```python
import torch

def _softmax(x, axis=-1):
    return torch.softmax(x, dim=axis)
def _gelu(x):
    return torch.nn.functional.gelu(x, approximate="tanh")
def _silu(x):
    return torch.nn.functional.silu(x)
def _sigmoid(x):
    return torch.sigmoid(x)
def _layernorm(x, axis=-1, eps=1e-5):
    m = x.mean(dim=axis, keepdim=True)
    v = x.var(dim=axis, keepdim=True, unbiased=False)
    return (x - m) / torch.sqrt(v + eps)
def _scatter_add(tgt, idx, src, axis=0):
    return tgt.clone().index_add_(axis, idx, src)
def _segment_sum(src, seg, n):
    out = torch.zeros((n,) + src.shape[1:], dtype=src.dtype)
    return out.index_add_(0, seg, src)
def _pad(x, pw):
    flat = tuple(v for pair in reversed(pw) for v in pair)
    return torch.nn.functional.pad(x, flat)

kernel_name = 'recurrent_scan__sliding_block_cached__glu_gated_reglu__decode'

def setup_inputs():

    _w = (lambda a: (lambda t: t.to(torch.bfloat16) if t.is_floating_point() else t)(torch.as_tensor(a)))
    def _A_setup():
        B, Sq, D = 2, 1, 576
        Hq, Hkv, Sk, Dh = 32, 16, 32768, 128
        assert Hq % Hkv == 0, (Hq, Hkv)
        return {
            "x": _w((lambda *s: torch.randn(*s, dtype=torch.bfloat16) * 0.2)(B, Sq, D)),
            "k_cache": _w((lambda *s: torch.randn(*s, dtype=torch.bfloat16) * 1.6)(B, Hkv, Sk, Dh)),
            "v_cache": _w((lambda *s: torch.randn(*s, dtype=torch.bfloat16) * 1.6)(B, Hkv, Sk, Dh)),
            "wq": _w((lambda *s: torch.randn(*s, dtype=torch.bfloat16) * 1.6)(D, Hq * Dh) * (D ** -0.5)),
            "wo": _w((lambda *s: torch.randn(*s, dtype=torch.bfloat16) * 1.6)(Hq * Dh, D) * ((Hq * Dh) ** -0.5)),
        }
    _A_in = _A_setup()

    def _B_setup():
        B, S, D, F = 2, 1, 576, 4608
        return {
            "x": _w((lambda *s: torch.randn(*s, dtype=torch.bfloat16) * 0.2)(B, S, D)),
            "W_gate": _w((lambda *s: torch.randn(*s, dtype=torch.bfloat16) * 0.8)(D, F) * (2.0 / D) ** 0.5),
            "W_up": _w((lambda *s: torch.randn(*s, dtype=torch.bfloat16) * 0.8)(D, F) * (2.0 / D) ** 0.5),
            "W_down": _w((lambda *s: torch.randn(*s, dtype=torch.bfloat16) * 0.8)(F, D) * (1.0 / F) ** 0.5),
        }
    _B_in = _B_setup()

    return {
        "A_x": _A_in["x"],
        "A_k_cache": _A_in["k_cache"],
        "A_v_cache": _A_in["v_cache"],
        "A_wq": _A_in["wq"],
        "A_wo": _A_in["wo"],
        "B_x": _B_in["x"],
        "B_W_gate": _B_in["W_gate"],
        "B_W_up": _B_in["W_up"],
        "B_W_down": _B_in["W_down"],
    }

def reference(A_x, A_k_cache, A_v_cache, A_wq, A_wo, B_x, B_W_gate, B_W_up, B_W_down):
    def _A_ref(x, k_cache, v_cache, wq, wo):
        B, Sq, D = x.shape
        Hq, Dh = 32, 128
        Hkv, Sk = k_cache.shape[1], k_cache.shape[2]
        W = min(4096, max(256, Sk // 4))
        rep = Hq // Hkv
        q = (lambda x, *d: x.permute(*d))((x @ wq).reshape(B, Sq, Hq, Dh), 0, 2, 1, 3)
        k = (lambda x, n, axis: torch.repeat_interleave(x, n, dim=axis))(k_cache[:, :, Sk - W:, :], rep, axis=1)
        v = (lambda x, n, axis: torch.repeat_interleave(x, n, dim=axis))(v_cache[:, :, Sk - W:, :], rep, axis=1)
        scores = torch.einsum("bhqd,bhkd->bhqk", q, k) * (Dh ** -0.5)
        p = _softmax(scores, axis=-1)
        o = torch.einsum("bhqk,bhkd->bhqd", p, v)
        return (lambda x, *d: x.permute(*d))(o, 0, 2, 1, 3).reshape(B, Sq, Hq * Dh) @ wo

    def _B_ref(x, W_gate, W_up, W_down):
        gate = torch.einsum("bsd,df->bsf", x, W_gate)
        up = torch.einsum("bsd,df->bsf", x, W_up)
        gate = gate * (lambda x, dt: x.to(dt))(gate > 0, gate.dtype)
        h = gate * up
        return torch.einsum("bsf,fd->bsd", h, W_down)

    x = A_x
    xn = _layernorm(x, axis=-1)
    s = _A_ref(xn, A_k_cache, A_v_cache, A_wq, A_wo)
    g = _silu(_B_ref(xn, B_W_gate, B_W_up, B_W_down))
    return x + s * g
```

```asm
; @launch grid=(256,1,1) block=(768,1,1) lds=30080
.amdgcn_target "amdgcn-amd-amdhsa--gfx950"
.text
.globl recurrent_scan__sliding_block_cached__glu_gated_reglu__decode_kernel
.p2align 8
.type recurrent_scan__sliding_block_cached__glu_gated_reglu__decode_kernel,@function
recurrent_scan__sliding_block_cached__glu_gated_reglu__decode_kernel:
    s_load_dwordx16 s[4:19], s[0:1], 0
    s_load_dwordx8 s[20:27], s[0:1], 64
    v_lshrrev_b32 v1, 6, v0
    s_cmp_ge_u32 s2, 256
    s_cbranch_scc1 L_end
    v_readfirstlane_b32 s3, v1
    v_and_b32 v2, 63, v0
    v_bfe_u32 v3, v0, 4, 2
    v_and_b32 v4, 15, v0
    v_and_b32 v5, 7, v0
    s_and_b32 s54, s2, 7
    s_lshr_b32 s55, s2, 3
    s_cmp_ge_u32 s3, 4
    s_cbranch_scc1 L_attn
    s_setprio 3
    s_cmp_ge_u32 s2, 234
    s_cbranch_scc1 L_h_light
    s_mul_i32 s77, s54, 26
    s_add_u32 s77, s77, s55
    s_and_b32 s66, s77, 7
    s_cmp_eq_u32 s66, 3
    s_cselect_b32 s78, 1, 0
    s_lshl3_add_u32 s66, s2, 4294965635
    s_cmp_ge_u32 s2, 208
    s_cselect_b32 s77, s66, s77
    s_cselect_b32 s78, 2, s78
    s_mul_i32 s79, s3, 144
    s_cselect_b32 s70, 80, 0
    s_add_u32 s71, s79, 144
    s_add_u32 s79, s79, s70
    s_cmp_eq_u32 s78, 1
    s_cselect_b32 s70, 64, 0
    s_sub_u32 s71, s71, s70
    s_cmp_lt_u32 s77, 136
    s_cselect_b32 s69, 64, 136
    s_cmp_lt_u32 s77, 64
    s_cselect_b32 s69, 0, s69
    s_movk_i32 s68, 9216
    s_cselect_b32 s68, 8192, s68
    s_sub_u32 s69, s77, s69
    v_bfe_u32 v24, v0, 3, 1
    v_lshl_add_u32 v24, v3, 2, v24
    v_mul_u32_u24 v25, s68, v24
    v_lshl_add_u32 v25, v5, 4, v25
    s_lshl_b32 s70, s68, 1
    v_add_u32 v26, s70, v25
    s_lshl_b32 s69, s69, 7
    s_mul_i32 s38, s71, s68
    s_mul_i32 s70, s79, s68
    s_add_u32 s69, s69, s70
    s_lshl_b32 s70, s68, 4
    s_mov_b32 s39, 0x20000
    s_cmp_lt_u32 s77, 136
    s_waitcnt lgkmcnt(0)
    s_cselect_b64 s[36:37], s[16:17], s[18:19]
    s_cmp_lt_u32 s77, 64
    s_cselect_b64 s[36:37], s[10:11], s[36:37]
    buffer_load_dwordx4 v[32:35], v25, s[36:39], s69 offen nt
    buffer_load_dwordx4 v[36:39], v26, s[36:39], s69 offen nt
    s_add_u32 s69, s69, s70
    buffer_load_dwordx4 v[40:43], v25, s[36:39], s69 offen nt
    buffer_load_dwordx4 v[44:47], v26, s[36:39], s69 offen nt
    s_add_u32 s69, s69, s70
    buffer_load_dwordx4 v[48:51], v25, s[36:39], s69 offen nt
    buffer_load_dwordx4 v[52:55], v26, s[36:39], s69 offen nt
    s_add_u32 s69, s69, s70
    buffer_load_dwordx4 v[56:59], v25, s[36:39], s69 offen nt
    buffer_load_dwordx4 v[60:63], v26, s[36:39], s69 offen nt
    s_add_u32 s69, s69, s70
    s_mov_b32 s44, s4
    s_mov_b32 s45, s5
    s_mov_b32 s46, 2304
    s_mov_b32 s47, 0x20000
    v_lshrrev_b32 v20, 5, v2
    v_and_b32 v21, 31, v2
    v_mul_u32_u24 v22, 1152, v20
    v_mul_u32_u24 v23, 36, v21
    v_add_u32 v22, v22, v23
    buffer_load_dwordx4 v[140:143], v22, s[44:47], 0 offen
    buffer_load_dwordx4 v[144:147], v22, s[44:47], 0 offen offset:16
    buffer_load_dword v148, v22, s[44:47], 0 offen offset:32
    s_setprio 1
    s_add_u32 s56, s26, 1441792
    s_addc_u32 s57, s27, 0
    s_load_dwordx2 s[14:15], s[56:57], 0
    v_lshrrev_b32 v6, 1, v5
    v_and_b32 v7, 1, v5
    v_lshlrev_b32 v7, 4, v7
    v_mov_b32 v8, 0xffff
    v_lshlrev_b32 v8, v7, v8
    v_cmp_eq_u32 s[52:53], 0, v6
    v_cmp_eq_u32 s[58:59], 1, v6
    v_cmp_eq_u32 s[60:61], 2, v6
    v_cmp_eq_u32 vcc, 3, v6
    v_mov_b32 v9, 0
    v_cndmask_b32 v12, 0, v8, s[52:53]
    v_cndmask_b32 v13, 0, v8, s[58:59]
    v_cndmask_b32 v14, 0, v8, s[60:61]
    v_cndmask_b32 v15, 0, v8, vcc
    v_lshlrev_b32 v7, 4, v2
    v_cmp_gt_u32 s[52:53], 8, v4
    s_and_b32 s62, s3, 3
    s_lshl_b32 s62, s62, 2
    v_mov_b32 v6, s62
    v_mov_b32 v0, 1
    s_lshr_b32 s62, s55, 4
    s_lshl1_add_u32 s62, s54, s62
    s_and_b32 s63, s55, 8
    s_lshl1_add_u32 s62, s63, s62
    s_and_b32 s63, s55, 7
    s_lshl_b32 s64, s3, 10
    v_add_u32 v8, s64, v7
    s_mov_b32 s28, s26
    s_mov_b32 s29, s27
    s_mov_b32 s30, 1073741824
    s_mov_b32 s31, 0x20000
    s_cmp_lg_u32 s78, 2
    s_cbranch_scc1 LH_1
    s_waitcnt lgkmcnt(0)
    s_barrier
    ds_write_b32 v6, v0 offset:32
LH_1:
    s_waitcnt vmcnt(10)
    buffer_load_dwordx4 v[64:67], v25, s[36:39], s69 offen nt
    s_waitcnt vmcnt(10)
    buffer_load_dwordx4 v[68:71], v26, s[36:39], s69 offen nt
    s_add_u32 s69, s69, s70
    s_cmp_lg_u32 s78, 1
    s_cbranch_scc1 LH_2
    s_waitcnt lgkmcnt(0)
    s_barrier
    ds_write_b32 v6, v0 offset:32
LH_2:
    s_waitcnt vmcnt(10)
    buffer_load_dwordx4 v[72:75], v25, s[36:39], s69 offen nt
    s_waitcnt vmcnt(10)
    buffer_load_dwordx4 v[76:79], v26, s[36:39], s69 offen nt
    s_add_u32 s69, s69, s70
    s_waitcnt vmcnt(10)
    buffer_load_dwordx4 v[80:83], v25, s[36:39], s69 offen nt
    s_waitcnt vmcnt(10)
    buffer_load_dwordx4 v[84:87], v26, s[36:39], s69 offen nt
    s_add_u32 s69, s69, s70
    s_waitcnt vmcnt(10)
    buffer_load_dwordx4 v[88:91], v25, s[36:39], s69 offen nt
    s_waitcnt vmcnt(10)
    buffer_load_dwordx4 v[92:95], v26, s[36:39], s69 offen nt
    s_add_u32 s69, s69, s70
    s_waitcnt vmcnt(7)
    buffer_load_dwordx4 v[96:99], v25, s[36:39], s69 offen nt
    s_waitcnt vmcnt(7)
    buffer_load_dwordx4 v[100:103], v26, s[36:39], s69 offen nt
    s_add_u32 s69, s69, s70
    s_cmp_lg_u32 s78, 0
    s_cbranch_scc1 LH_3
    s_waitcnt lgkmcnt(0)
    s_barrier
    ds_write_b32 v6, v0 offset:32
LH_3:
    s_add_u32 s14, s14, 0x7f4a7c15
    s_addc_u32 s15, s15, 0x9e3779b9
    s_and_b32 s32, s14, 0xff
    s_bfe_u32 s33, s14, 0x80008
    s_bfe_u32 s34, s14, 0x80010
    s_lshr_b32 s35, s14, 24
    s_waitcnt vmcnt(10)
    v_lshlrev_b32 v104, 16, v140
    v_and_b32 v105, 0xffff0000, v140
    v_lshlrev_b32 v106, 16, v141
    v_and_b32 v107, 0xffff0000, v141
    v_lshlrev_b32 v108, 16, v142
    v_and_b32 v109, 0xffff0000, v142
    v_lshlrev_b32 v110, 16, v143
    v_and_b32 v111, 0xffff0000, v143
    v_lshlrev_b32 v112, 16, v144
    v_and_b32 v113, 0xffff0000, v144
    v_lshlrev_b32 v114, 16, v145
    v_and_b32 v115, 0xffff0000, v145
    v_lshlrev_b32 v116, 16, v146
    v_and_b32 v117, 0xffff0000, v146
    v_lshlrev_b32 v118, 16, v147
    v_and_b32 v119, 0xffff0000, v147
    v_lshlrev_b32 v120, 16, v148
    v_and_b32 v121, 0xffff0000, v148
    v_add_f32 v122, v104, v105
    v_add_f32 v122, v122, v106
    v_add_f32 v122, v122, v107
    v_add_f32 v122, v122, v108
    v_add_f32 v122, v122, v109
    v_add_f32 v122, v122, v110
    v_add_f32 v122, v122, v111
    v_add_f32 v122, v122, v112
    v_add_f32 v122, v122, v113
    v_add_f32 v122, v122, v114
    v_add_f32 v122, v122, v115
    v_add_f32 v122, v122, v116
    v_add_f32 v122, v122, v117
    v_add_f32 v122, v122, v118
    v_add_f32 v122, v122, v119
    v_add_f32 v122, v122, v120
    v_add_f32 v122, v122, v121
    s_nop 1
    v_add_f32_dpp v122, v122, v122 quad_perm:[1,0,3,2] row_mask:0xf bank_mask:0xf
    s_nop 1
    v_add_f32_dpp v122, v122, v122 quad_perm:[2,3,0,1] row_mask:0xf bank_mask:0xf
    s_nop 1
    v_add_f32_dpp v122, v122, v122 row_half_mirror row_mask:0xf bank_mask:0xf
    s_nop 1
    v_add_f32_dpp v122, v122, v122 row_mirror row_mask:0xf bank_mask:0xf
    v_mov_b32 v123, v122
    s_nop 1
    v_permlane16_swap_b32 v122, v123
    s_nop 1
    v_add_f32 v122, v122, v123
    v_mul_f32 v122, 0x3ae38e39, v122
    v_sub_f32 v124, v104, v122
    v_mul_f32 v125, v124, v124
    v_sub_f32 v124, v105, v122
    v_fmac_f32 v125, v124, v124
    v_sub_f32 v124, v106, v122
    v_fmac_f32 v125, v124, v124
    v_sub_f32 v124, v107, v122
    v_fmac_f32 v125, v124, v124
    v_sub_f32 v124, v108, v122
    v_fmac_f32 v125, v124, v124
    v_sub_f32 v124, v109, v122
    v_fmac_f32 v125, v124, v124
    v_sub_f32 v124, v110, v122
    v_fmac_f32 v125, v124, v124
    v_sub_f32 v124, v111, v122
    v_fmac_f32 v125, v124, v124
    v_sub_f32 v124, v112, v122
    v_fmac_f32 v125, v124, v124
    v_sub_f32 v124, v113, v122
    v_fmac_f32 v125, v124, v124
    v_sub_f32 v124, v114, v122
    v_fmac_f32 v125, v124, v124
    v_sub_f32 v124, v115, v122
    v_fmac_f32 v125, v124, v124
    v_sub_f32 v124, v116, v122
    v_fmac_f32 v125, v124, v124
    v_sub_f32 v124, v117, v122
    v_fmac_f32 v125, v124, v124
    v_sub_f32 v124, v118, v122
    v_fmac_f32 v125, v124, v124
    v_sub_f32 v124, v119, v122
    v_fmac_f32 v125, v124, v124
    v_sub_f32 v124, v120, v122
    v_fmac_f32 v125, v124, v124
    v_sub_f32 v124, v121, v122
    v_fmac_f32 v125, v124, v124
    s_nop 1
    v_add_f32_dpp v125, v125, v125 quad_perm:[1,0,3,2] row_mask:0xf bank_mask:0xf
    s_nop 1
    v_add_f32_dpp v125, v125, v125 quad_perm:[2,3,0,1] row_mask:0xf bank_mask:0xf
    s_nop 1
    v_add_f32_dpp v125, v125, v125 row_half_mirror row_mask:0xf bank_mask:0xf
    s_nop 1
    v_add_f32_dpp v125, v125, v125 row_mirror row_mask:0xf bank_mask:0xf
    v_mov_b32 v123, v125
    s_nop 1
    v_permlane16_swap_b32 v125, v123
    s_nop 1
    v_add_f32 v125, v125, v123
    v_mul_f32 v125, 0x3ae38e39, v125
    v_cvt_pk_bf16_f32 v122, v122, v125
    v_and_b32 v125, 0xffff0000, v122
    v_lshlrev_b32 v122, 16, v122
    v_add_f32 v125, 0x3727c5ac, v125
    v_cvt_pk_bf16_f32 v125, v125, v125
    v_and_b32 v125, 0xffff0000, v125
    v_sqrt_f32 v125, v125
    s_nop 0
    v_cvt_pk_bf16_f32 v125, v125, v125
    v_and_b32 v125, 0xffff0000, v125
    v_rcp_f32 v125, v125
    v_sub_f32 v104, v104, v122
    v_sub_f32 v105, v105, v122
    v_sub_f32 v106, v106, v122
    v_sub_f32 v107, v107, v122
    v_sub_f32 v108, v108, v122
    v_sub_f32 v109, v109, v122
    v_sub_f32 v110, v110, v122
    v_sub_f32 v111, v111, v122
    v_sub_f32 v112, v112, v122
    v_sub_f32 v113, v113, v122
    v_sub_f32 v114, v114, v122
    v_sub_f32 v115, v115, v122
    v_sub_f32 v116, v116, v122
    v_sub_f32 v117, v117, v122
    v_sub_f32 v118, v118, v122
    v_sub_f32 v119, v119, v122
    v_sub_f32 v120, v120, v122
    v_sub_f32 v121, v121, v122
    v_cvt_pk_bf16_f32 v140, v104, v105
    v_cvt_pk_bf16_f32 v141, v106, v107
    v_cvt_pk_bf16_f32 v142, v108, v109
    v_cvt_pk_bf16_f32 v143, v110, v111
    v_cvt_pk_bf16_f32 v144, v112, v113
    v_cvt_pk_bf16_f32 v145, v114, v115
    v_cvt_pk_bf16_f32 v146, v116, v117
    v_cvt_pk_bf16_f32 v147, v118, v119
    v_cvt_pk_bf16_f32 v148, v120, v121
    v_lshlrev_b32 v104, 16, v140
    v_and_b32 v105, 0xffff0000, v140
    v_lshlrev_b32 v106, 16, v141
    v_and_b32 v107, 0xffff0000, v141
    v_lshlrev_b32 v108, 16, v142
    v_and_b32 v109, 0xffff0000, v142
    v_lshlrev_b32 v110, 16, v143
    v_and_b32 v111, 0xffff0000, v143
    v_lshlrev_b32 v112, 16, v144
    v_and_b32 v113, 0xffff0000, v144
    v_lshlrev_b32 v114, 16, v145
    v_and_b32 v115, 0xffff0000, v145
    v_lshlrev_b32 v116, 16, v146
    v_and_b32 v117, 0xffff0000, v146
    v_lshlrev_b32 v118, 16, v147
    v_and_b32 v119, 0xffff0000, v147
    v_lshlrev_b32 v120, 16, v148
    v_and_b32 v121, 0xffff0000, v148
    v_mul_f32 v104, v104, v125
    v_mul_f32 v105, v105, v125
    v_mul_f32 v106, v106, v125
    v_mul_f32 v107, v107, v125
    v_mul_f32 v108, v108, v125
    v_mul_f32 v109, v109, v125
    v_mul_f32 v110, v110, v125
    v_mul_f32 v111, v111, v125
    v_mul_f32 v112, v112, v125
    v_mul_f32 v113, v113, v125
    v_mul_f32 v114, v114, v125
    v_mul_f32 v115, v115, v125
    v_mul_f32 v116, v116, v125
    v_mul_f32 v117, v117, v125
    v_mul_f32 v118, v118, v125
    v_mul_f32 v119, v119, v125
    v_mul_f32 v120, v120, v125
    v_mul_f32 v121, v121, v125
    v_cvt_pk_bf16_f32 v104, v104, v104
    v_cvt_pk_bf16_f32 v105, v105, v105
    v_cvt_pk_bf16_f32 v106, v106, v106
    v_cvt_pk_bf16_f32 v107, v107, v107
    v_cvt_pk_bf16_f32 v108, v108, v108
    v_cvt_pk_bf16_f32 v109, v109, v109
    v_cvt_pk_bf16_f32 v110, v110, v110
    v_cvt_pk_bf16_f32 v111, v111, v111
    v_cvt_pk_bf16_f32 v112, v112, v112
    v_cvt_pk_bf16_f32 v113, v113, v113
    v_cvt_pk_bf16_f32 v114, v114, v114
    v_cvt_pk_bf16_f32 v115, v115, v115
    v_cvt_pk_bf16_f32 v116, v116, v116
    v_cvt_pk_bf16_f32 v117, v117, v117
    v_cvt_pk_bf16_f32 v118, v118, v118
    v_cvt_pk_bf16_f32 v119, v119, v119
    v_cvt_pk_bf16_f32 v120, v120, v120
    v_cvt_pk_bf16_f32 v121, v121, v121
    v_mul_u32_u24 v22, 2688, v20
    v_mul_u32_u24 v23, 72, v21
    v_mul_u32_u24 v21, 12, v21
    v_add_u32 v21, v22, v21
    v_add_u32 v22, v22, v23
    ds_write_b64 v22, v[104:105] offset:1024
    ds_write_b64 v22, v[106:107] offset:1032
    ds_write_b64 v22, v[108:109] offset:1040
    ds_write_b64 v22, v[110:111] offset:1048
    ds_write_b64 v22, v[112:113] offset:1056
    ds_write_b64 v22, v[114:115] offset:1064
    ds_write_b64 v22, v[116:117] offset:1072
    ds_write_b64 v22, v[118:119] offset:1080
    ds_write_b64 v22, v[120:121] offset:1088
    ds_write_b32 v21, v9 offset:3328
    ds_write_b32 v21, v9 offset:3332
    ds_write_b32 v21, v9 offset:3336
    v_lshrrev_b32 v27, 3, v4
    v_mul_u32_u24 v28, 2688, v27
    v_lshl_add_u32 v28, v3, 4, v28
    s_lshl_b32 s71, s79, 2
    v_add_u32 v28, s71, v28
    s_waitcnt lgkmcnt(0)
    ds_read_b128 v[104:107], v28 offset:1024
    ds_read_b128 v[108:111], v28 offset:1088
    ds_read_b128 v[112:115], v28 offset:1152
    ds_read_b128 v[116:119], v28 offset:1216
    ds_read_b128 v[120:123], v28 offset:1280
    ds_read_b128 v[124:127], v28 offset:1344
    ds_read_b128 v[128:131], v28 offset:1408
    ds_read_b128 v[132:135], v28 offset:1472
    ds_read_b128 v[136:139], v28 offset:1536
    s_waitcnt lgkmcnt(0)
    v_and_b32 v140, v104, v12
    v_and_b32 v141, v104, v13
    v_and_b32 v142, v104, v14
    v_and_b32 v143, v104, v15
    v_and_b32 v144, v105, v12
    v_and_b32 v145, v105, v13
    v_and_b32 v146, v105, v14
    v_and_b32 v147, v105, v15
    s_waitcnt vmcnt(17)
    v_mfma_f32_16x16x32_bf16 v[16:19], v[140:143], v[32:35], 0
    v_mfma_f32_16x16x32_bf16 v[20:23], v[144:147], v[32:35], 0
    v_and_b32 v140, v106, v12
    v_and_b32 v141, v106, v13
    v_and_b32 v142, v106, v14
    v_and_b32 v143, v106, v15
    v_and_b32 v144, v107, v12
    v_and_b32 v145, v107, v13
    v_and_b32 v146, v107, v14
    v_and_b32 v147, v107, v15
    s_waitcnt vmcnt(16)
    v_mfma_f32_16x16x32_bf16 v[16:19], v[140:143], v[36:39], v[16:19]
    v_mfma_f32_16x16x32_bf16 v[20:23], v[144:147], v[36:39], v[20:23]
    v_and_b32 v140, v108, v12
    v_and_b32 v141, v108, v13
    v_and_b32 v142, v108, v14
    v_and_b32 v143, v108, v15
    v_and_b32 v144, v109, v12
    v_and_b32 v145, v109, v13
    v_and_b32 v146, v109, v14
    v_and_b32 v147, v109, v15
    s_waitcnt vmcnt(15)
    v_mfma_f32_16x16x32_bf16 v[16:19], v[140:143], v[40:43], v[16:19]
    v_mfma_f32_16x16x32_bf16 v[20:23], v[144:147], v[40:43], v[20:23]
    v_and_b32 v140, v110, v12
    v_and_b32 v141, v110, v13
    v_and_b32 v142, v110, v14
    v_and_b32 v143, v110, v15
    v_and_b32 v144, v111, v12
    v_and_b32 v145, v111, v13
    v_and_b32 v146, v111, v14
    v_and_b32 v147, v111, v15
    s_waitcnt vmcnt(14)
    v_mfma_f32_16x16x32_bf16 v[16:19], v[140:143], v[44:47], v[16:19]
    v_mfma_f32_16x16x32_bf16 v[20:23], v[144:147], v[44:47], v[20:23]
    v_and_b32 v140, v112, v12
    v_and_b32 v141, v112, v13
    v_and_b32 v142, v112, v14
    v_and_b32 v143, v112, v15
    v_and_b32 v144, v113, v12
    v_and_b32 v145, v113, v13
    v_and_b32 v146, v113, v14
    v_and_b32 v147, v113, v15
    s_waitcnt vmcnt(13)
    v_mfma_f32_16x16x32_bf16 v[16:19], v[140:143], v[48:51], v[16:19]
    v_mfma_f32_16x16x32_bf16 v[20:23], v[144:147], v[48:51], v[20:23]
    v_and_b32 v140, v114, v12
    v_and_b32 v141, v114, v13
    v_and_b32 v142, v114, v14
    v_and_b32 v143, v114, v15
    v_and_b32 v144, v115, v12
    v_and_b32 v145, v115, v13
    v_and_b32 v146, v115, v14
    v_and_b32 v147, v115, v15
    s_waitcnt vmcnt(12)
    v_mfma_f32_16x16x32_bf16 v[16:19], v[140:143], v[52:55], v[16:19]
    v_mfma_f32_16x16x32_bf16 v[20:23], v[144:147], v[52:55], v[20:23]
    v_and_b32 v140, v116, v12
    v_and_b32 v141, v116, v13
    v_and_b32 v142, v116, v14
    v_and_b32 v143, v116, v15
    v_and_b32 v144, v117, v12
    v_and_b32 v145, v117, v13
    v_and_b32 v146, v117, v14
    v_and_b32 v147, v117, v15
    s_waitcnt vmcnt(11)
    v_mfma_f32_16x16x32_bf16 v[16:19], v[140:143], v[56:59], v[16:19]
    v_mfma_f32_16x16x32_bf16 v[20:23], v[144:147], v[56:59], v[20:23]
    v_and_b32 v140, v118, v12
    v_and_b32 v141, v118, v13
    v_and_b32 v142, v118, v14
    v_and_b32 v143, v118, v15
    v_and_b32 v144, v119, v12
    v_and_b32 v145, v119, v13
    v_and_b32 v146, v119, v14
    v_and_b32 v147, v119, v15
    s_waitcnt vmcnt(10)
    v_mfma_f32_16x16x32_bf16 v[16:19], v[140:143], v[60:63], v[16:19]
    v_mfma_f32_16x16x32_bf16 v[20:23], v[144:147], v[60:63], v[20:23]
    v_and_b32 v140, v120, v12
    v_and_b32 v141, v120, v13
    v_and_b32 v142, v120, v14
    v_and_b32 v143, v120, v15
    v_and_b32 v144, v121, v12
    v_and_b32 v145, v121, v13
    v_and_b32 v146, v121, v14
    v_and_b32 v147, v121, v15
    s_waitcnt vmcnt(9)
    v_mfma_f32_16x16x32_bf16 v[16:19], v[140:143], v[64:67], v[16:19]
    v_mfma_f32_16x16x32_bf16 v[20:23], v[144:147], v[64:67], v[20:23]
    v_and_b32 v140, v122, v12
    v_and_b32 v141, v122, v13
    v_and_b32 v142, v122, v14
    v_and_b32 v143, v122, v15
    v_and_b32 v144, v123, v12
    v_and_b32 v145, v123, v13
    v_and_b32 v146, v123, v14
    v_and_b32 v147, v123, v15
    s_waitcnt vmcnt(8)
    v_mfma_f32_16x16x32_bf16 v[16:19], v[140:143], v[68:71], v[16:19]
    v_mfma_f32_16x16x32_bf16 v[20:23], v[144:147], v[68:71], v[20:23]
    v_and_b32 v140, v124, v12
    v_and_b32 v141, v124, v13
    v_and_b32 v142, v124, v14
    v_and_b32 v143, v124, v15
    v_and_b32 v144, v125, v12
    v_and_b32 v145, v125, v13
    v_and_b32 v146, v125, v14
    v_and_b32 v147, v125, v15
    s_waitcnt vmcnt(7)
    v_mfma_f32_16x16x32_bf16 v[16:19], v[140:143], v[72:75], v[16:19]
    v_mfma_f32_16x16x32_bf16 v[20:23], v[144:147], v[72:75], v[20:23]
    v_and_b32 v140, v126, v12
    v_and_b32 v141, v126, v13
    v_and_b32 v142, v126, v14
    v_and_b32 v143, v126, v15
    v_and_b32 v144, v127, v12
    v_and_b32 v145, v127, v13
    v_and_b32 v146, v127, v14
    v_and_b32 v147, v127, v15
    s_waitcnt vmcnt(6)
    v_mfma_f32_16x16x32_bf16 v[16:19], v[140:143], v[76:79], v[16:19]
    v_mfma_f32_16x16x32_bf16 v[20:23], v[144:147], v[76:79], v[20:23]
    v_and_b32 v140, v128, v12
    v_and_b32 v141, v128, v13
    v_and_b32 v142, v128, v14
    v_and_b32 v143, v128, v15
    v_and_b32 v144, v129, v12
    v_and_b32 v145, v129, v13
    v_and_b32 v146, v129, v14
    v_and_b32 v147, v129, v15
    s_waitcnt vmcnt(5)
    v_mfma_f32_16x16x32_bf16 v[16:19], v[140:143], v[80:83], v[16:19]
    v_mfma_f32_16x16x32_bf16 v[20:23], v[144:147], v[80:83], v[20:23]
    v_and_b32 v140, v130, v12
    v_and_b32 v141, v130, v13
    v_and_b32 v142, v130, v14
    v_and_b32 v143, v130, v15
    v_and_b32 v144, v131, v12
    v_and_b32 v145, v131, v13
    v_and_b32 v146, v131, v14
    v_and_b32 v147, v131, v15
    s_waitcnt vmcnt(4)
    v_mfma_f32_16x16x32_bf16 v[16:19], v[140:143], v[84:87], v[16:19]
    v_mfma_f32_16x16x32_bf16 v[20:23], v[144:147], v[84:87], v[20:23]
    v_and_b32 v140, v132, v12
    v_and_b32 v141, v132, v13
    v_and_b32 v142, v132, v14
    v_and_b32 v143, v132, v15
    v_and_b32 v144, v133, v12
    v_and_b32 v145, v133, v13
    v_and_b32 v146, v133, v14
    v_and_b32 v147, v133, v15
    s_waitcnt vmcnt(3)
    v_mfma_f32_16x16x32_bf16 v[16:19], v[140:143], v[88:91], v[16:19]
    v_mfma_f32_16x16x32_bf16 v[20:23], v[144:147], v[88:91], v[20:23]
    v_and_b32 v140, v134, v12
    v_and_b32 v141, v134, v13
    v_and_b32 v142, v134, v14
    v_and_b32 v143, v134, v15
    v_and_b32 v144, v135, v12
    v_and_b32 v145, v135, v13
    v_and_b32 v146, v135, v14
    v_and_b32 v147, v135, v15
    s_waitcnt vmcnt(2)
    v_mfma_f32_16x16x32_bf16 v[16:19], v[140:143], v[92:95], v[16:19]
    v_mfma_f32_16x16x32_bf16 v[20:23], v[144:147], v[92:95], v[20:23]
    v_and_b32 v140, v136, v12
    v_and_b32 v141, v136, v13
    v_and_b32 v142, v136, v14
    v_and_b32 v143, v136, v15
    v_and_b32 v144, v137, v12
    v_and_b32 v145, v137, v13
    v_and_b32 v146, v137, v14
    v_and_b32 v147, v137, v15
    s_waitcnt vmcnt(1)
    v_mfma_f32_16x16x32_bf16 v[16:19], v[140:143], v[96:99], v[16:19]
    v_mfma_f32_16x16x32_bf16 v[20:23], v[144:147], v[96:99], v[20:23]
    v_and_b32 v140, v138, v12
    v_and_b32 v141, v138, v13
    v_and_b32 v142, v138, v14
    v_and_b32 v143, v138, v15
    v_and_b32 v144, v139, v12
    v_and_b32 v145, v139, v13
    v_and_b32 v146, v139, v14
    v_and_b32 v147, v139, v15
    s_waitcnt vmcnt(0)
    v_mfma_f32_16x16x32_bf16 v[16:19], v[140:143], v[100:103], v[16:19]
    v_mfma_f32_16x16x32_bf16 v[20:23], v[144:147], v[100:103], v[20:23]
    v_lshrrev_b32 v24, 1, v3
    v_and_b32 v25, 1, v3
    v_lshlrev_b32 v26, 16, v24
    v_lshl_add_u32 v26, v4, 5, v26
    v_lshl_add_u32 v26, v25, 4, v26
    v_mov_b32 v27, 0xffffff00
    s_lshl_b32 s70, s77, 8
    s_cmp_eq_u32 s78, 2
    s_cselect_b32 s71, 131072, 0
    s_add_u32 s70, s70, s71
    s_nop 0
    v_add_f32_dpp v104, v20, v16 row_ror:8 row_mask:0xf bank_mask:0xf
    v_add_f32_dpp v105, v21, v17 row_ror:8 row_mask:0xf bank_mask:0xf
    v_add_f32_dpp v106, v22, v18 row_ror:8 row_mask:0xf bank_mask:0xf
    v_add_f32_dpp v107, v23, v19 row_ror:8 row_mask:0xf bank_mask:0xf
    s_mov_b64 exec, s[52:53]
    ds_write_b128 v8, v[104:107] offset:9600
    s_mov_b64 exec, 1
    ds_add_rtn_u32 v1, v9, v0 offset:4
    s_mov_b64 exec, -1
    ds_read_b128 v[108:111], v7 offset:9600
    ds_read_b128 v[112:115], v7 offset:10624
    ds_read_b128 v[116:119], v7 offset:11648
    ds_read_b128 v[120:123], v7 offset:12672
    s_waitcnt lgkmcnt(4)
    v_readfirstlane_b32 s61, v1
    s_cmp_lg_u32 s61, 3
    s_cbranch_scc1 L_h_p1done
    s_waitcnt lgkmcnt(2)
    v_pk_add_f32 v[104:105], v[108:109], v[112:113]
    v_pk_add_f32 v[106:107], v[110:111], v[114:115]
    s_waitcnt lgkmcnt(0)
    v_pk_add_f32 v[116:117], v[116:117], v[120:121]
    v_pk_add_f32 v[118:119], v[118:119], v[122:123]
    v_pk_add_f32 v[104:105], v[104:105], v[116:117]
    v_pk_add_f32 v[106:107], v[106:107], v[118:119]
    s_cmp_lg_u32 s78, 0
    s_cbranch_scc1 L_z_half
    v_cvt_pk_bf16_f32 v104, v104, v105
    v_cvt_pk_bf16_f32 v106, v106, v107
    v_and_b32 v105, 0xffff0000, v104
    v_and_b32 v107, 0xffff0000, v106
    v_lshlrev_b32 v104, 16, v104
    v_lshlrev_b32 v106, 16, v106
L_z_half:
    v_and_or_b32 v104, v104, v27, s32
    v_and_or_b32 v105, v105, v27, s33
    v_and_or_b32 v106, v106, v27, s34
    v_and_or_b32 v107, v107, v27, s35
    s_mov_b64 exec, s[52:53]
    buffer_store_dwordx4 v[104:107], v26, s[28:31], s70 offen sc1
    s_mov_b64 exec, -1
    s_branch L_h_p1done
L_h_light:
    s_waitcnt lgkmcnt(0)
    s_add_u32 s56, s26, 1441792
    s_addc_u32 s57, s27, 0
    s_load_dwordx2 s[14:15], s[56:57], 0
    v_lshrrev_b32 v6, 1, v5
    v_and_b32 v7, 1, v5
    v_lshlrev_b32 v7, 4, v7
    v_mov_b32 v8, 0xffff
    v_lshlrev_b32 v8, v7, v8
    v_cmp_eq_u32 s[52:53], 0, v6
    v_cmp_eq_u32 s[58:59], 1, v6
    v_cmp_eq_u32 s[60:61], 2, v6
    v_cmp_eq_u32 vcc, 3, v6
    v_mov_b32 v9, 0
    v_cndmask_b32 v12, 0, v8, s[52:53]
    v_cndmask_b32 v13, 0, v8, s[58:59]
    v_cndmask_b32 v14, 0, v8, s[60:61]
    v_cndmask_b32 v15, 0, v8, vcc
    v_lshlrev_b32 v7, 4, v2
    v_cmp_gt_u32 s[52:53], 8, v4
    s_and_b32 s62, s3, 3
    s_lshl_b32 s62, s62, 2
    v_mov_b32 v6, s62
    v_mov_b32 v0, 1
    s_lshr_b32 s62, s55, 4
    s_lshl1_add_u32 s62, s54, s62
    s_and_b32 s63, s55, 8
    s_lshl1_add_u32 s62, s63, s62
    s_and_b32 s63, s55, 7
    s_lshl_b32 s64, s3, 10
    v_add_u32 v8, s64, v7
    s_mov_b32 s28, s26
    s_mov_b32 s29, s27
    s_mov_b32 s30, 1073741824
    s_mov_b32 s31, 0x20000
    s_waitcnt lgkmcnt(0)
    s_barrier
    ds_write_b32 v6, v0 offset:32
    s_add_u32 s14, s14, 0x7f4a7c15
    s_addc_u32 s15, s15, 0x9e3779b9
    s_and_b32 s32, s14, 0xff
    s_bfe_u32 s33, s14, 0x80008
    s_bfe_u32 s34, s14, 0x80010
    s_lshr_b32 s35, s14, 24
L_h_p1done:
    s_mov_b32 s60, 2000000
LW_4:
    ds_read_b32 v1, v6 offset:48
    s_waitcnt lgkmcnt(0)
    v_readfirstlane_b32 s61, v1
    s_cmp_ge_u32 s61, 1
    s_cbranch_scc1 LD_5
    s_sleep 4
    s_sub_u32 s60, s60, 1
    s_cbranch_scc0 LW_4
LD_5:
    s_cmp_lg_u32 s3, 0
    s_cbranch_scc1 L_p3
    s_lshr_b32 s70, s62, 4
    s_lshl_b32 s70, s70, 16
    s_and_b32 s71, s62, 15
    s_lshl_b32 s72, s71, 10
    s_add_u32 s70, s70, s72
    s_add_u32 s70, s70, 0
    s_lshl_b32 s71, s71, 2
    v_add_u32 v20, s71, v3
    v_and_b32 v20, 7, v20
    v_cmp_eq_u32 vcc, 3, v20
    v_mov_b32 v21, 131072
    v_lshlrev_b32 v23, 3, v2
    v_cndmask_b32 v22, 0, 1.0, vcc
    v_cndmask_b32 v21, 0, v21, vcc
    v_add_u32 v21, v21, v7
    s_cbranch_vccnz L_q2
    s_mov_b32 s60, 2000000
LP_6:
    buffer_load_dwordx4 v[24:27], v7, s[28:31], s70 offen sc1
    s_waitcnt vmcnt(0)
    v_xor_b32 v24, s32, v24
    v_xor_b32 v25, s33, v25
    v_xor_b32 v26, s34, v26
    v_xor_b32 v27, s35, v27
    v_or3_b32 v32, v24, v25, v26
    v_or_b32 v33, v32, v27
    v_and_b32 v34, 0xff, v33
    v_cmp_ne_u32 vcc, 0, v34
    s_cbranch_vccz LK_7
    s_sleep 4
    s_sub_u32 s60, s60, 1
    s_cbranch_scc0 LP_6
LK_7:
    s_branch L_q1
L_q2:
    s_mov_b32 s60, 2000000
LP_9:
    buffer_load_dwordx4 v[24:27], v7, s[28:31], s70 offen sc1
    buffer_load_dwordx4 v[28:31], v21, s[28:31], s70 offen sc1
    s_waitcnt vmcnt(0)
    v_xor_b32 v24, s32, v24
    v_xor_b32 v25, s33, v25
    v_xor_b32 v26, s34, v26
    v_xor_b32 v27, s35, v27
    v_xor_b32 v28, s32, v28
    v_xor_b32 v29, s33, v29
    v_xor_b32 v30, s34, v30
    v_xor_b32 v31, s35, v31
    v_or3_b32 v32, v24, v25, v26
    v_or3_b32 v33, v27, v28, v29
    v_or3_b32 v34, v32, v33, v30
    v_or_b32 v35, v34, v31
    v_and_b32 v36, 0xff, v35
    v_cmp_ne_u32 vcc, 0, v36
    s_cbranch_vccz LK_10
    s_sleep 4
    s_sub_u32 s60, s60, 1
    s_cbranch_scc0 LP_9
LK_10:
    v_fmac_f32 v24, v22, v28
    v_fmac_f32 v25, v22, v29
    v_fmac_f32 v26, v22, v30
    v_fmac_f32 v27, v22, v31
L_q1:
    v_cvt_pk_bf16_f32 v24, v24, v25
    v_cvt_pk_bf16_f32 v25, v26, v27
    ds_write_b64 v23, v[24:25] offset:128
    s_waitcnt lgkmcnt(0)
    ds_write_b32 v9, v0 offset:12
L_p3:
    s_cmp_ge_u32 s2, 252
    s_cbranch_scc1 L_fin
    s_setprio 1
    v_lshrrev_b32 v24, 3, v4
    v_lshl_add_u32 v25, v3, 2, v24
    v_mul_u32_u24 v25, 1152, v25
    v_lshl_add_u32 v25, v5, 4, v25
    v_mul_u32_u24 v28, 1600, v24
    v_lshl_add_u32 v28, v3, 4, v28
    v_lshrrev_b32 v26, 1, v3
    v_and_b32 v27, 1, v3
    v_lshlrev_b32 v26, 8, v26
    v_lshl_add_u32 v26, v4, 5, v26
    v_lshl_add_u32 v26, v27, 4, v26
    v_lshl_add_u32 v31, v24, 12, v7
    s_lshl_b32 s64, s3, 10
    s_and_b32 s65, s3, 4
    s_lshl_b32 s65, s65, 5
    s_add_u32 s64, s64, s65
    v_add_u32 v8, s64, v7
    v_mov_b32 v90, 0xffffff00
    v_lshlrev_b32 v93, 7, v4
    v_lshl_add_u32 v93, v3, 4, v93
    v_lshlrev_b32 v94, 4, v4
    s_cmp_lt_u32 s55, 18
    s_cbranch_scc1 L_wo
    s_sub_u32 s65, s2, 144
    s_lshl_b32 s79, s65, 9
    s_add_u32 s79, s79, 1310720
    s_mul_i32 s66, s65, 171
    s_lshr_b32 s66, s66, 11
    s_mul_i32 s67, s66, 12
    s_sub_u32 s67, s65, s67
    s_mul_i32 s67, s67, 384
    s_mul_i32 s68, s3, 48
    s_mov_b32 s73, s68
    s_add_u32 s67, s67, s68
    s_lshl_b32 s68, s68, 2
    v_add_u32 v28, s68, v28
    s_mov_b32 s40, s20
    s_mov_b32 s41, s21
    s_mov_b32 s42, 5308416
    s_mov_b32 s43, 0x20000
    s_mul_i32 s71, s67, 1152
    s_lshl_b32 s66, s66, 7
    s_sub_u32 s72, s67, s73
    s_add_u32 s67, s71, s66
    s_sub_u32 s68, s3, 1
    s_cmp_ge_u32 s68, 3
    s_cbranch_scc1 L_h_done
    s_lshl_b32 s68, s68, 7
    s_add_u32 s72, s72, s68
    v_lshrrev_b32 v20, 5, v2
    v_and_b32 v21, 31, v2
    v_lshlrev_b32 v22, 16, v20
    v_lshl_add_u32 v22, v21, 4, v22
    v_lshl_add_u32 v29, v21, 2, s72
    v_bfe_u32 v29, v29, 6, 3
    v_cmp_eq_u32 vcc, 3, v29
    v_mov_b32 v29, 131072
    s_lshl_b32 s69, s72, 2
    v_cndmask_b32 v30, 0, 1.0, vcc
    v_cndmask_b32 v29, 0, v29, vcc
    v_add_u32 v29, v29, v22
    s_add_u32 s69, s69, 16384
    s_add_u32 s70, s69, 18432
    s_lshl_b32 s68, s68, 2
    v_mul_u32_u24 v23, 1600, v20
    v_lshl_add_u32 v23, v21, 4, v23
    v_add_u32 v23, s68, v23
    s_cbranch_vccnz L_h4
    s_mov_b32 s60, 2000000
LP_12:
    buffer_load_dwordx4 v[32:35], v22, s[28:31], s69 offen sc1
    buffer_load_dwordx4 v[40:43], v22, s[28:31], s70 offen sc1
    s_waitcnt vmcnt(0)
    v_xor_b32 v32, s32, v32
    v_xor_b32 v33, s33, v33
    v_xor_b32 v34, s34, v34
    v_xor_b32 v35, s35, v35
    v_xor_b32 v40, s32, v40
    v_xor_b32 v41, s33, v41
    v_xor_b32 v42, s34, v42
    v_xor_b32 v43, s35, v43
    v_or3_b32 v48, v32, v33, v34
    v_or3_b32 v49, v35, v40, v41
    v_or3_b32 v50, v48, v49, v42
    v_or_b32 v51, v50, v43
    v_and_b32 v52, 0xff, v51
    v_cmp_ne_u32 vcc, 0, v52
    s_cbranch_vccz LK_13
    s_sleep 16
    s_sub_u32 s60, s60, 1
    s_cbranch_scc0 LP_12
LK_13:
    s_branch L_h2
L_h4:
    s_mov_b32 s60, 2000000
LP_15:
    buffer_load_dwordx4 v[32:35], v22, s[28:31], s69 offen sc1
    buffer_load_dwordx4 v[36:39], v29, s[28:31], s69 offen sc1
    buffer_load_dwordx4 v[40:43], v22, s[28:31], s70 offen sc1
    buffer_load_dwordx4 v[44:47], v29, s[28:31], s70 offen sc1
    s_waitcnt vmcnt(0)
    v_xor_b32 v32, s32, v32
    v_xor_b32 v33, s33, v33
    v_xor_b32 v34, s34, v34
    v_xor_b32 v35, s35, v35
    v_xor_b32 v36, s32, v36
    v_xor_b32 v37, s33, v37
    v_xor_b32 v38, s34, v38
    v_xor_b32 v39, s35, v39
    v_xor_b32 v40, s32, v40
    v_xor_b32 v41, s33, v41
    v_xor_b32 v42, s34, v42
    v_xor_b32 v43, s35, v43
    v_xor_b32 v44, s32, v44
    v_xor_b32 v45, s33, v45
    v_xor_b32 v46, s34, v46
    v_xor_b32 v47, s35, v47
    v_or3_b32 v48, v32, v33, v34
    v_or3_b32 v49, v35, v36, v37
    v_or3_b32 v50, v38, v39, v40
    v_or3_b32 v51, v41, v42, v43
    v_or3_b32 v52, v44, v45, v46
    v_or3_b32 v53, v48, v49, v50
    v_or3_b32 v54, v51, v52, v47
    v_or_b32 v55, v53, v54
    v_and_b32 v56, 0xff, v55
    v_cmp_ne_u32 vcc, 0, v56
    s_cbranch_vccz LK_16
    s_sleep 16
    s_sub_u32 s60, s60, 1
    s_cbranch_scc0 LP_15
LK_16:
    v_fmac_f32 v32, v30, v36
    v_fmac_f32 v40, v30, v44
    v_fmac_f32 v33, v30, v37
    v_fmac_f32 v41, v30, v45
    v_fmac_f32 v34, v30, v38
    v_fmac_f32 v42, v30, v46
    v_fmac_f32 v35, v30, v39
    v_fmac_f32 v43, v30, v47
L_h2:
    v_cvt_pk_bf16_f32 v32, v32, v40
    v_cvt_pk_bf16_f32 v33, v33, v41
    v_cvt_pk_bf16_f32 v34, v34, v42
    v_cvt_pk_bf16_f32 v35, v35, v43
    v_lshlrev_b32 v36, 16, v32
    v_and_b32 v40, 0xffff0000, v32
    v_lshlrev_b32 v37, 16, v33
    v_and_b32 v41, 0xffff0000, v33
    v_lshlrev_b32 v38, 16, v34
    v_and_b32 v42, 0xffff0000, v34
    v_lshlrev_b32 v39, 16, v35
    v_and_b32 v43, 0xffff0000, v35
    v_cmp_lt_f32 s[56:57], 0, v36
    v_cmp_lt_f32 s[58:59], 0, v37
    v_cmp_lt_f32 s[72:73], 0, v38
    v_cmp_lt_f32 s[74:75], 0, v39
    s_nop 0
    v_cndmask_b32 v44, 0, 1.0, s[56:57]
    v_cndmask_b32 v45, 0, 1.0, s[58:59]
    v_cndmask_b32 v46, 0, 1.0, s[72:73]
    v_cndmask_b32 v47, 0, 1.0, s[74:75]
    v_mul_f32 v36, v36, v44
    v_mul_f32 v37, v37, v45
    v_mul_f32 v38, v38, v46
    v_mul_f32 v39, v39, v47
    v_mul_f32 v36, v36, v40
    v_mul_f32 v37, v37, v41
    v_mul_f32 v38, v38, v42
    v_mul_f32 v39, v39, v43
    v_cvt_pk_bf16_f32 v36, v36, v36
    v_cvt_pk_bf16_f32 v37, v37, v37
    v_cvt_pk_bf16_f32 v38, v38, v38
    v_cvt_pk_bf16_f32 v39, v39, v39
    ds_write_b128 v23, v[36:39] offset:6400
    s_mov_b64 exec, 1
    ds_add_u32 v9, v0 offset:100
    s_mov_b64 exec, -1
L_h_done:
    s_mov_b32 s60, 2000000
LW_18:
    ds_read_b32 v1, v9 offset:100
    s_waitcnt lgkmcnt(0)
    v_readfirstlane_b32 s61, v1
    s_cmp_ge_u32 s61, 3
    s_cbranch_scc1 LD_19
    s_sleep 2
    s_sub_u32 s60, s60, 1
    s_cbranch_scc0 LW_18
LD_19:
    s_mov_b32 s60, 2000000
LW_20:
    ds_read_b32 v1, v9 offset:20
    s_waitcnt lgkmcnt(0)
    v_readfirstlane_b32 s61, v1
    s_cmp_ge_u32 s61, 8
    s_cbranch_scc1 LD_21
    s_sleep 1
    s_sub_u32 s60, s60, 1
    s_cbranch_scc0 LW_20
LD_21:
    buffer_load_dwordx4 v[104:107], v25, s[40:43], s67 offen offset:0 nt
    buffer_load_dwordx4 v[108:111], v25, s[40:43], s67 offen offset:2304 nt
    s_add_u32 s67, s67, 18432
    buffer_load_dwordx4 v[112:115], v25, s[40:43], s67 offen offset:0 nt
    s_mov_b32 s60, 2000000
LW_22:
    ds_read_b32 v1, v9 offset:24
    s_waitcnt lgkmcnt(0)
    v_readfirstlane_b32 s61, v1
    s_cmp_ge_u32 s61, 1
    s_cbranch_scc1 LD_23
    s_sleep 1
    s_sub_u32 s60, s60, 1
    s_cbranch_scc0 LW_22
LD_23:
    buffer_load_dwordx4 v[116:119], v25, s[40:43], s67 offen offset:2304 nt
    s_add_u32 s67, s67, 18432
    buffer_load_dwordx4 v[120:123], v25, s[40:43], s67 offen offset:0 nt
    buffer_load_dwordx4 v[124:127], v25, s[40:43], s67 offen offset:2304 nt
    s_add_u32 s67, s67, 18432
    ds_read_b128 v[48:51], v28 offset:6400
    ds_read_b128 v[52:55], v28 offset:6464
    ds_read_b128 v[56:59], v28 offset:6528
    s_waitcnt lgkmcnt(0)
    v_and_b32 v32, v48, v12
    v_and_b32 v33, v48, v13
    v_and_b32 v34, v48, v14
    v_and_b32 v35, v48, v15
    v_and_b32 v36, v49, v12
    v_and_b32 v37, v49, v13
    v_and_b32 v38, v49, v14
    v_and_b32 v39, v49, v15
    s_waitcnt vmcnt(5)
    v_mfma_f32_16x16x32_bf16 v[16:19], v[32:35], v[104:107], 0
    v_mfma_f32_16x16x32_bf16 v[20:23], v[36:39], v[104:107], 0
    v_and_b32 v32, v50, v12
    v_and_b32 v33, v50, v13
    v_and_b32 v34, v50, v14
    v_and_b32 v35, v50, v15
    v_and_b32 v36, v51, v12
    v_and_b32 v37, v51, v13
    v_and_b32 v38, v51, v14
    v_and_b32 v39, v51, v15
    s_waitcnt vmcnt(4)
    v_mfma_f32_16x16x32_bf16 v[16:19], v[32:35], v[108:111], v[16:19]
    v_mfma_f32_16x16x32_bf16 v[20:23], v[36:39], v[108:111], v[20:23]
    v_and_b32 v32, v52, v12
    v_and_b32 v33, v52, v13
    v_and_b32 v34, v52, v14
    v_and_b32 v35, v52, v15
    v_and_b32 v36, v53, v12
    v_and_b32 v37, v53, v13
    v_and_b32 v38, v53, v14
    v_and_b32 v39, v53, v15
    s_waitcnt vmcnt(3)
    v_mfma_f32_16x16x32_bf16 v[16:19], v[32:35], v[112:115], v[16:19]
    v_mfma_f32_16x16x32_bf16 v[20:23], v[36:39], v[112:115], v[20:23]
    v_and_b32 v32, v54, v12
    v_and_b32 v33, v54, v13
    v_and_b32 v34, v54, v14
    v_and_b32 v35, v54, v15
    v_and_b32 v36, v55, v12
    v_and_b32 v37, v55, v13
    v_and_b32 v38, v55, v14
    v_and_b32 v39, v55, v15
    s_waitcnt vmcnt(2)
    v_mfma_f32_16x16x32_bf16 v[16:19], v[32:35], v[116:119], v[16:19]
    v_mfma_f32_16x16x32_bf16 v[20:23], v[36:39], v[116:119], v[20:23]
    v_and_b32 v32, v56, v12
    v_and_b32 v33, v56, v13
    v_and_b32 v34, v56, v14
    v_and_b32 v35, v56, v15
    v_and_b32 v36, v57, v12
    v_and_b32 v37, v57, v13
    v_and_b32 v38, v57, v14
    v_and_b32 v39, v57, v15
    s_waitcnt vmcnt(1)
    v_mfma_f32_16x16x32_bf16 v[16:19], v[32:35], v[120:123], v[16:19]
    v_mfma_f32_16x16x32_bf16 v[20:23], v[36:39], v[120:123], v[20:23]
    v_and_b32 v32, v58, v12
    v_and_b32 v33, v58, v13
    v_and_b32 v34, v58, v14
    v_and_b32 v35, v58, v15
    v_and_b32 v36, v59, v12
    v_and_b32 v37, v59, v13
    v_and_b32 v38, v59, v14
    v_and_b32 v39, v59, v15
    s_waitcnt vmcnt(0)
    v_mfma_f32_16x16x32_bf16 v[16:19], v[32:35], v[124:127], v[16:19]
    v_mfma_f32_16x16x32_bf16 v[20:23], v[36:39], v[124:127], v[20:23]
    s_branch L_p3fin
L_wo:
    s_cmp_ge_u32 s55, 9
    s_cselect_b32 s67, 1, 0
    s_cselect_b32 s66, 9, 0
    s_sub_u32 s66, s55, s66
    s_lshl1_add_u32 s67, s54, s67
    s_lshl4_add_u32 s65, s66, s67
    s_lshl_b32 s79, s65, 9
    s_add_u32 s79, s79, 1366016
    s_lshl_b32 s68, s3, 7
    v_add_u32 v28, s68, v28
    s_mov_b32 s40, s12
    s_mov_b32 s41, s13
    s_mov_b32 s42, 4718592
    s_mov_b32 s43, 0x20000
    s_lshl_b32 s69, s67, 8
    s_lshl_b32 s70, s3, 5
    s_add_u32 s69, s69, s70
    s_mul_i32 s69, s69, 1152
    s_lshl_b32 s66, s66, 7
    s_add_u32 s69, s69, s66
    s_add_u32 s74, s69, 18432
    s_mul_i32 s70, s67, 17408
    s_add_u32 s70, s70, 262144
    s_lshl_b32 s71, s3, 11
    s_add_u32 s71, s71, s70
    s_lshr_b32 s75, s3, 2
    s_lshl_b32 s75, s75, 8
    s_add_u32 s75, s75, s70
    s_add_u32 s75, s75, 0x4000
    s_mov_b32 s60, 2000000
LW_24:
    ds_read_b32 v1, v9 offset:20
    s_waitcnt lgkmcnt(0)
    v_readfirstlane_b32 s61, v1
    s_cmp_ge_u32 s61, 8
    s_cbranch_scc1 LD_25
    s_sleep 1
    s_sub_u32 s60, s60, 1
    s_cbranch_scc0 LW_24
LD_25:
    buffer_load_dwordx4 v[104:107], v25, s[40:43], s69 offen offset:0 nt
    buffer_load_dwordx4 v[108:111], v25, s[40:43], s69 offen offset:2304 nt
    buffer_load_dwordx4 v[112:115], v25, s[40:43], s74 offen offset:0 nt
    buffer_load_dwordx4 v[116:119], v25, s[40:43], s74 offen offset:2304 nt
    s_mov_b32 s60, 2000000
LW_26:
    ds_read_b32 v1, v9 offset:24
    s_waitcnt lgkmcnt(0)
    v_readfirstlane_b32 s61, v1
    s_cmp_ge_u32 s61, 1
    s_cbranch_scc1 LD_27
    s_sleep 1
    s_sub_u32 s60, s60, 1
    s_cbranch_scc0 LW_26
LD_27:
    s_waitcnt vmcnt(1)
    buffer_load_dwordx4 v[64:67], v94, s[28:31], s75 offen sc1
    buffer_load_dwordx4 v[48:51], v7, s[28:31], s71 offen sc1
    buffer_load_dwordx4 v[52:55], v7, s[28:31], s71 offen offset:1024 sc1
    buffer_load_dwordx4 v[68:71], v94, s[28:31], s75 offen sc1
    s_mov_b32 s60, 48
    s_waitcnt vmcnt(3)
    v_cmp_ne_u64 s[56:57], v[66:67], s[14:15]
    v_xor_b32 v40, s32, v64
    v_xor_b32 v41, s33, v65
    v_or_b32 v46, v40, v41
    v_and_b32 v46, 0xff, v46
    v_cmp_ne_u32 vcc, 0, v46
    s_or_b64 s[56:57], s[56:57], vcc
    s_cbranch_scc0 L_ml_w
L_ml_loop:
    buffer_load_dwordx4 v[64:67], v94, s[28:31], s75 offen sc1
    s_waitcnt vmcnt(1)
    v_cmp_ne_u64 s[56:57], v[70:71], s[14:15]
    v_xor_b32 v40, s32, v68
    v_xor_b32 v41, s33, v69
    v_or_b32 v46, v40, v41
    v_and_b32 v46, 0xff, v46
    v_cmp_ne_u32 vcc, 0, v46
    s_or_b64 s[56:57], s[56:57], vcc
    s_cbranch_scc0 L_ml_got
    buffer_load_dwordx4 v[68:71], v94, s[28:31], s75 offen sc1
    s_waitcnt vmcnt(1)
    v_cmp_ne_u64 s[56:57], v[66:67], s[14:15]
    v_xor_b32 v40, s32, v64
    v_xor_b32 v41, s33, v65
    v_or_b32 v46, v40, v41
    v_and_b32 v46, 0xff, v46
    v_cmp_ne_u32 vcc, 0, v46
    s_or_b64 s[56:57], s[56:57], vcc
    s_cbranch_scc0 L_ml_got
    s_sub_u32 s60, s60, 1
    s_cbranch_scc0 L_ml_loop
    s_branch L_generic
L_ml_got:
    buffer_load_dwordx4 v[48:51], v7, s[28:31], s71 offen sc1
    buffer_load_dwordx4 v[52:55], v7, s[28:31], s71 offen offset:1024 sc1
L_ml_w:
    v_max_f32_dpp v44, v40, v40 quad_perm:[1,0,3,2] row_mask:0xf bank_mask:0xf
    s_nop 1
    v_max_f32_dpp v44, v44, v44 quad_perm:[2,3,0,1] row_mask:0xf bank_mask:0xf
    s_nop 1
    v_max_f32_dpp v44, v44, v44 row_half_mirror row_mask:0xf bank_mask:0xf
    v_sub_f32 v44, v40, v44
    v_mul_f32 v44, 0x3fb8aa3b, v44
    v_exp_f32 v44, v44
    s_nop 0
    v_mul_f32 v47, v44, v41
    s_nop 1
    v_add_f32_dpp v47, v47, v47 quad_perm:[1,0,3,2] row_mask:0xf bank_mask:0xf
    s_nop 1
    v_add_f32_dpp v47, v47, v47 quad_perm:[2,3,0,1] row_mask:0xf bank_mask:0xf
    s_nop 1
    v_add_f32_dpp v47, v47, v47 row_half_mirror row_mask:0xf bank_mask:0xf
    v_rcp_f32 v47, v47
    s_nop 0
    v_mul_f32 v44, v44, v47
    v_mul_f32 v45, v44, 1.0
    s_waitcnt vmcnt(0)
    v_xor_b32 v48, s32, v48
    v_xor_b32 v49, s33, v49
    v_xor_b32 v50, s34, v50
    v_xor_b32 v51, s35, v51
    v_xor_b32 v52, s32, v52
    v_xor_b32 v53, s33, v53
    v_xor_b32 v54, s34, v54
    v_xor_b32 v55, s35, v55
    v_or3_b32 v56, v48, v49, v50
    v_or3_b32 v57, v51, v52, v53
    v_or3_b32 v58, v56, v57, v54
    v_or_b32 v59, v58, v55
    v_and_b32 v60, 0xff, v59
    v_cmp_ne_u32 vcc, 0, v60
    s_cbranch_vccz L_wo_post
L_generic:
    s_mov_b32 s60, 2000000
LP_28:
    s_and_b32 s61, s60, 3
    s_cmp_gt_u32 s60, 1999996
    s_cselect_b32 s61, 0, s61
    s_cmp_eq_u32 s61, 1
    s_cselect_b32 s61, 278528, 0
    s_cselect_b32 s78, 64, 1024
    s_cselect_b64 vcc, -1, 0
    s_add_u32 s72, s71, s61
    s_add_u32 s73, s75, s61
    v_cndmask_b32 v95, v7, v93, vcc
    s_add_u32 s78, s78, s72
    buffer_load_dwordx4 v[40:43], v94, s[28:31], s73 offen sc1
    buffer_load_dwordx4 v[48:51], v95, s[28:31], s72 offen sc1
    buffer_load_dwordx4 v[52:55], v95, s[28:31], s78 offen sc1
    s_waitcnt vmcnt(0)
    v_xor_b32 v40, s32, v40
    v_xor_b32 v41, s33, v41
    v_xor_b32 v48, s32, v48
    v_xor_b32 v49, s33, v49
    v_xor_b32 v50, s34, v50
    v_xor_b32 v51, s35, v51
    v_xor_b32 v52, s32, v52
    v_xor_b32 v53, s33, v53
    v_xor_b32 v54, s34, v54
    v_xor_b32 v55, s35, v55
    v_xor_b32 v42, s14, v42
    v_xor_b32 v43, s15, v43
    v_or3_b32 v56, v40, v41, v48
    v_or3_b32 v57, v49, v50, v51
    v_or3_b32 v58, v52, v53, v54
    v_or3_b32 v59, v56, v57, v58
    v_or_b32 v60, v59, v55
    v_and_b32 v61, 0xff, v60
    v_or3_b32 v61, v61, v42, v43
    v_cmp_ne_u32 vcc, 0, v61
    s_cbranch_vccz LK_29
    s_sleep 1
    s_sub_u32 s60, s60, 1
    s_cbranch_scc0 LP_28
LK_29:
    v_max_f32_dpp v44, v40, v40 quad_perm:[1,0,3,2] row_mask:0xf bank_mask:0xf
    s_nop 1
    v_max_f32_dpp v44, v44, v44 quad_perm:[2,3,0,1] row_mask:0xf bank_mask:0xf
    s_nop 1
    v_max_f32_dpp v44, v44, v44 row_half_mirror row_mask:0xf bank_mask:0xf
    v_sub_f32 v44, v40, v44
    v_mul_f32 v44, 0x3fb8aa3b, v44
    v_exp_f32 v44, v44
    s_nop 0
    v_mul_f32 v47, v44, v41
    s_nop 1
    v_add_f32_dpp v47, v47, v47 quad_perm:[1,0,3,2] row_mask:0xf bank_mask:0xf
    s_nop 1
    v_add_f32_dpp v47, v47, v47 quad_perm:[2,3,0,1] row_mask:0xf bank_mask:0xf
    s_nop 1
    v_add_f32_dpp v47, v47, v47 row_half_mirror row_mask:0xf bank_mask:0xf
    v_rcp_f32 v47, v47
    s_nop 0
    v_mul_f32 v44, v44, v47
    v_mul_f32 v45, v44, 1.0
L_wo_post:
    v_pk_mul_f32 v[48:49], v[44:45], v[48:49]
    v_pk_mul_f32 v[50:51], v[44:45], v[50:51]
    v_pk_mul_f32 v[52:53], v[44:45], v[52:53]
    v_pk_mul_f32 v[54:55], v[44:45], v[54:55]
    v_add_f32_dpp v56, v48, v48 row_shl:4 row_mask:0xf bank_mask:0x5
    v_add_f32_dpp v57, v50, v50 row_shl:4 row_mask:0xf bank_mask:0x5
    v_add_f32_dpp v58, v52, v52 row_shl:4 row_mask:0xf bank_mask:0x5
    v_add_f32_dpp v59, v54, v54 row_shl:4 row_mask:0xf bank_mask:0x5
    v_add_f32_dpp v56, v49, v49 row_shr:4 row_mask:0xf bank_mask:0xa
    v_add_f32_dpp v57, v51, v51 row_shr:4 row_mask:0xf bank_mask:0xa
    v_add_f32_dpp v58, v53, v53 row_shr:4 row_mask:0xf bank_mask:0xa
    v_add_f32_dpp v59, v55, v55 row_shr:4 row_mask:0xf bank_mask:0xa
    v_add_f32_dpp v56, v56, v56 quad_perm:[1,0,3,2] row_mask:0xf bank_mask:0xf
    v_add_f32_dpp v57, v57, v57 quad_perm:[1,0,3,2] row_mask:0xf bank_mask:0xf
    v_add_f32_dpp v58, v58, v58 quad_perm:[1,0,3,2] row_mask:0xf bank_mask:0xf
    v_add_f32_dpp v59, v59, v59 quad_perm:[1,0,3,2] row_mask:0xf bank_mask:0xf
    v_add_f32_dpp v56, v56, v56 quad_perm:[2,3,0,1] row_mask:0xf bank_mask:0xf
    v_add_f32_dpp v57, v57, v57 quad_perm:[2,3,0,1] row_mask:0xf bank_mask:0xf
    v_add_f32_dpp v58, v58, v58 quad_perm:[2,3,0,1] row_mask:0xf bank_mask:0xf
    v_add_f32_dpp v59, v59, v59 quad_perm:[2,3,0,1] row_mask:0xf bank_mask:0xf
    v_cvt_pk_bf16_f32 v56, v56, v56
    v_cvt_pk_bf16_f32 v57, v57, v57
    v_cvt_pk_bf16_f32 v58, v58, v58
    v_cvt_pk_bf16_f32 v59, v59, v59
    v_and_b32 v120, v56, v12
    v_and_b32 v121, v56, v13
    v_and_b32_dpp v122, v56, v14 row_shr:4 row_mask:0xf bank_mask:0xf bound_ctrl:0
    v_and_b32_dpp v123, v56, v15 row_shr:4 row_mask:0xf bank_mask:0xf bound_ctrl:0
    v_and_b32_dpp v124, v56, v12 row_shl:4 row_mask:0xf bank_mask:0xf bound_ctrl:0
    v_and_b32_dpp v125, v56, v13 row_shl:4 row_mask:0xf bank_mask:0xf bound_ctrl:0
    v_and_b32 v126, v56, v14
    v_and_b32 v127, v56, v15
    v_and_b32 v128, v57, v12
    v_and_b32 v129, v57, v13
    v_and_b32_dpp v130, v57, v14 row_shr:4 row_mask:0xf bank_mask:0xf bound_ctrl:0
    v_and_b32_dpp v131, v57, v15 row_shr:4 row_mask:0xf bank_mask:0xf bound_ctrl:0
    v_and_b32_dpp v132, v57, v12 row_shl:4 row_mask:0xf bank_mask:0xf bound_ctrl:0
    v_and_b32_dpp v133, v57, v13 row_shl:4 row_mask:0xf bank_mask:0xf bound_ctrl:0
    v_and_b32 v134, v57, v14
    v_and_b32 v135, v57, v15
    s_waitcnt vmcnt(3)
    v_mfma_f32_16x16x32_bf16 v[16:19], v[120:123], v[104:107], 0
    v_mfma_f32_16x16x32_bf16 v[20:23], v[124:127], v[104:107], 0
    v_and_b32 v136, v58, v12
    v_and_b32 v137, v58, v13
    v_and_b32_dpp v138, v58, v14 row_shr:4 row_mask:0xf bank_mask:0xf bound_ctrl:0
    v_and_b32_dpp v139, v58, v15 row_shr:4 row_mask:0xf bank_mask:0xf bound_ctrl:0
    v_and_b32_dpp v140, v58, v12 row_shl:4 row_mask:0xf bank_mask:0xf bound_ctrl:0
    v_and_b32_dpp v141, v58, v13 row_shl:4 row_mask:0xf bank_mask:0xf bound_ctrl:0
    v_and_b32 v142, v58, v14
    v_and_b32 v143, v58, v15
    s_waitcnt vmcnt(2)
    v_mfma_f32_16x16x32_bf16 v[16:19], v[128:131], v[108:111], v[16:19]
    v_mfma_f32_16x16x32_bf16 v[20:23], v[132:135], v[108:111], v[20:23]
    v_and_b32 v144, v59, v12
    v_and_b32 v145, v59, v13
    v_and_b32_dpp v146, v59, v14 row_shr:4 row_mask:0xf bank_mask:0xf bound_ctrl:0
    v_and_b32_dpp v147, v59, v15 row_shr:4 row_mask:0xf bank_mask:0xf bound_ctrl:0
    v_and_b32_dpp v148, v59, v12 row_shl:4 row_mask:0xf bank_mask:0xf bound_ctrl:0
    v_and_b32_dpp v149, v59, v13 row_shl:4 row_mask:0xf bank_mask:0xf bound_ctrl:0
    v_and_b32 v150, v59, v14
    v_and_b32 v151, v59, v15
    s_waitcnt vmcnt(1)
    v_mfma_f32_16x16x32_bf16 v[16:19], v[136:139], v[112:115], v[16:19]
    v_mfma_f32_16x16x32_bf16 v[20:23], v[140:143], v[112:115], v[20:23]
    s_waitcnt vmcnt(0)
    v_mfma_f32_16x16x32_bf16 v[16:19], v[144:147], v[116:119], v[16:19]
    v_mfma_f32_16x16x32_bf16 v[20:23], v[148:151], v[116:119], v[20:23]
L_p3fin:
    s_nop 7
    v_add_f32_dpp v64, v20, v16 row_ror:8 row_mask:0xf bank_mask:0xf
    v_add_f32_dpp v65, v21, v17 row_ror:8 row_mask:0xf bank_mask:0xf
    v_add_f32_dpp v66, v22, v18 row_ror:8 row_mask:0xf bank_mask:0xf
    v_add_f32_dpp v67, v23, v19 row_ror:8 row_mask:0xf bank_mask:0xf
    s_mov_b64 exec, s[52:53]
    ds_write_b128 v8, v[64:67] offset:13696
    s_mov_b64 exec, 1
    ds_add_rtn_u32 v1, v9, v0 offset:8
    s_mov_b64 exec, -1
    ds_read_b128 v[68:71], v31 offset:13696
    ds_read_b128 v[72:75], v31 offset:14720
    ds_read_b128 v[76:79], v31 offset:15744
    ds_read_b128 v[80:83], v31 offset:16768
    s_waitcnt lgkmcnt(4)
    v_readfirstlane_b32 s61, v1
    s_cmp_lg_u32 s61, 7
    s_cbranch_scc1 L_fin
    s_waitcnt lgkmcnt(2)
    v_pk_add_f32 v[64:65], v[68:69], v[72:73]
    v_pk_add_f32 v[66:67], v[70:71], v[74:75]
    s_waitcnt lgkmcnt(0)
    v_pk_add_f32 v[76:77], v[76:77], v[80:81]
    v_pk_add_f32 v[78:79], v[78:79], v[82:83]
    v_pk_add_f32 v[64:65], v[64:65], v[76:77]
    v_pk_add_f32 v[66:67], v[66:67], v[78:79]
    s_nop 0
    v_add_f32_dpp v64, v64, v64 row_ror:8 row_mask:0xf bank_mask:0xf
    v_add_f32_dpp v65, v65, v65 row_ror:8 row_mask:0xf bank_mask:0xf
    v_add_f32_dpp v66, v66, v66 row_ror:8 row_mask:0xf bank_mask:0xf
    v_add_f32_dpp v67, v67, v67 row_ror:8 row_mask:0xf bank_mask:0xf
    v_and_or_b32 v64, v64, v90, s32
    v_and_or_b32 v65, v65, v90, s33
    v_and_or_b32 v66, v66, v90, s34
    v_and_or_b32 v67, v67, v90, s35
    s_mov_b64 exec, s[52:53]
    buffer_store_dwordx4 v[64:67], v26, s[28:31], s79 offen sc1
    s_mov_b64 exec, -1
    ds_write_b32 v9, v0 offset:28
    s_branch L_fin
L_attn:
    s_waitcnt lgkmcnt(0)
    s_add_u32 s56, s26, 1441792
    s_addc_u32 s57, s27, 0
    s_load_dwordx2 s[14:15], s[56:57], 0
    v_lshrrev_b32 v6, 1, v5
    v_and_b32 v7, 1, v5
    v_lshlrev_b32 v7, 4, v7
    v_mov_b32 v8, 0xffff
    v_lshlrev_b32 v8, v7, v8
    v_cmp_eq_u32 s[52:53], 0, v6
    v_cmp_eq_u32 s[58:59], 1, v6
    v_cmp_eq_u32 s[60:61], 2, v6
    v_cmp_eq_u32 vcc, 3, v6
    v_mov_b32 v9, 0
    v_cndmask_b32 v12, 0, v8, s[52:53]
    v_cndmask_b32 v13, 0, v8, s[58:59]
    v_cndmask_b32 v14, 0, v8, s[60:61]
    v_cndmask_b32 v15, 0, v8, vcc
    v_lshlrev_b32 v7, 4, v2
    v_cmp_gt_u32 s[52:53], 8, v4
    s_and_b32 s62, s3, 3
    s_lshl_b32 s62, s62, 2
    v_mov_b32 v6, s62
    v_mov_b32 v0, 1
    s_lshr_b32 s62, s55, 4
    s_lshl1_add_u32 s62, s54, s62
    s_and_b32 s63, s55, 8
    s_lshl1_add_u32 s62, s63, s62
    s_and_b32 s63, s55, 7
    s_lshl_b32 s64, s3, 10
    v_add_u32 v8, s64, v7
    s_mov_b32 s28, s26
    s_mov_b32 s29, s27
    s_mov_b32 s30, 1073741824
    s_mov_b32 s31, 0x20000
    s_sub_u32 s64, s3, 4
    s_cmp_lg_u32 s64, 0
    s_cbranch_scc1 L_noinit
    v_lshlrev_b32 v10, 2, v2
    v_and_b32 v10, 0x7c, v10
    ds_write_b32 v10, v9
L_noinit:
    s_lshr_b32 s76, s64, 2
    s_lshl_b32 s76, s76, 4
    v_add_u32 v6, s76, v6
    s_mov_b32 s36, s6
    s_mov_b32 s37, s7
    s_mov_b32 s38, 268435456
    s_mov_b32 s39, 0x20000
    s_mov_b32 s40, s8
    s_mov_b32 s41, s9
    s_mov_b32 s42, 268435456
    s_mov_b32 s43, 0x20000
    s_lshl_b32 s65, s62, 23
    s_lshl_b32 s66, s63, 17
    s_add_u32 s65, s65, 7340032
    v_lshrrev_b32 v10, 1, v4
    v_lshlrev_b32 v10, 8, v10
    v_and_b32 v11, 1, v4
    v_lshl_add_u32 v10, v11, 6, v10
    v_lshl_add_u32 v10, v3, 4, v10
    v_lshlrev_b32 v11, 9, v3
    v_lshl_add_u32 v11, v4, 4, v11
    s_lshr_b32 s66, s55, 1
    s_mul_i32 s66, s66, 3
    s_add_u32 s66, s66, s54
    s_and_b32 s67, s64, 3
    s_add_u32 s66, s66, s67
    s_mul_i32 s72, s62, 64
    s_lshl3_add_u32 s72, s63, s72
    s_lshl3_add_u32 s72, s76, s72
    s_add_u32 s67, s66, 0
    s_and_b32 s67, s67, 7
    s_add_u32 s67, s67, s72
    s_add_u32 s67, s67, 0
    s_and_b32 s67, s67, 255
    s_lshl_b32 s67, s67, 12
    s_add_u32 s68, s67, s65
    s_add_u32 s67, s66, 4
    s_and_b32 s67, s67, 7
    s_add_u32 s67, s67, s72
    s_add_u32 s67, s67, 0
    s_and_b32 s67, s67, 255
    s_lshl_b32 s67, s67, 12
    s_add_u32 s69, s67, s65
    s_add_u32 s67, s66, 0
    s_and_b32 s67, s67, 7
    s_add_u32 s67, s67, s72
    s_add_u32 s67, s67, 64
    s_and_b32 s67, s67, 255
    s_lshl_b32 s67, s67, 12
    s_add_u32 s70, s67, s65
    s_add_u32 s67, s66, 4
    s_and_b32 s67, s67, 7
    s_add_u32 s67, s67, s72
    s_add_u32 s67, s67, 64
    s_and_b32 s67, s67, 255
    s_lshl_b32 s67, s67, 12
    s_add_u32 s71, s67, s65
    s_waitcnt lgkmcnt(0)
    s_barrier
    s_mov_b32 s60, 2000000
LW_31:
    ds_read_b32 v1, v6 offset:32
    s_waitcnt lgkmcnt(0)
    v_readfirstlane_b32 s61, v1
    s_cmp_ge_u32 s61, 1
    s_cbranch_scc1 LD_32
    s_sleep 1
    s_sub_u32 s60, s60, 1
    s_cbranch_scc0 LW_31
LD_32:
    s_setprio 2
    buffer_load_dwordx4 v[32:35], v10, s[36:39], s68 offen offset:0 nt
    buffer_load_dwordx4 v[36:39], v10, s[36:39], s68 offen offset:128 nt
    buffer_load_dwordx4 v[40:43], v10, s[36:39], s68 offen offset:2048 nt
    buffer_load_dwordx4 v[44:47], v10, s[36:39], s68 offen offset:2176 nt
    buffer_load_dwordx4 v[48:51], v10, s[36:39], s69 offen offset:0 nt
    buffer_load_dwordx4 v[52:55], v10, s[36:39], s69 offen offset:128 nt
    buffer_load_dwordx4 v[56:59], v10, s[36:39], s69 offen offset:2048 nt
    buffer_load_dwordx4 v[60:63], v10, s[36:39], s69 offen offset:2176 nt
    s_add_u32 s14, s14, 0x7f4a7c15
    s_addc_u32 s15, s15, 0x9e3779b9
    s_and_b32 s32, s14, 0xff
    s_bfe_u32 s33, s14, 0x80008
    s_bfe_u32 s34, s14, 0x80010
    s_lshr_b32 s35, s14, 24
    s_and_b32 s56, s62, 15
    s_mul_i32 s56, s56, 17408
    s_add_u32 s56, s56, 262144
    s_and_b32 s57, s55, 15
    s_lshl4_add_u32 s58, s57, s56
    s_add_u32 s58, s58, 0x4000
    s_lshl_b32 s57, s57, 7
    s_add_u32 s57, s56, s57
    s_add_u32 s57, s57, 278528
    s_sub_u32 s56, s58, 0x4000
    s_add_u32 s59, s58, 278528
    s_waitcnt vmcnt(7)
    buffer_load_dwordx4 v[64:67], v10, s[36:39], s70 offen offset:0 nt
    s_waitcnt vmcnt(7)
    buffer_load_dwordx4 v[68:71], v10, s[36:39], s70 offen offset:128 nt
    s_waitcnt vmcnt(7)
    buffer_load_dwordx4 v[72:75], v10, s[36:39], s70 offen offset:2048 nt
    s_waitcnt vmcnt(7)
    buffer_load_dwordx4 v[76:79], v10, s[36:39], s70 offen offset:2176 nt
    s_waitcnt vmcnt(7)
    buffer_load_dwordx4 v[80:83], v10, s[36:39], s71 offen offset:0 nt
    s_waitcnt vmcnt(7)
    buffer_load_dwordx4 v[84:87], v10, s[36:39], s71 offen offset:128 nt
    s_waitcnt vmcnt(7)
    buffer_load_dwordx4 v[88:91], v10, s[36:39], s71 offen offset:2048 nt
    s_waitcnt vmcnt(7)
    buffer_load_dwordx4 v[92:95], v10, s[36:39], s71 offen offset:2176 nt
    s_waitcnt vmcnt(7)
    buffer_load_dwordx4 v[96:99], v11, s[40:43], s68 offen offset:0 nt
    s_waitcnt vmcnt(7)
    buffer_load_dwordx4 v[100:103], v11, s[40:43], s68 offen offset:256 nt
    s_waitcnt vmcnt(7)
    buffer_load_dwordx4 v[104:107], v11, s[40:43], s68 offen offset:2048 nt
    s_waitcnt vmcnt(7)
    buffer_load_dwordx4 v[108:111], v11, s[40:43], s68 offen offset:2304 nt
    s_waitcnt vmcnt(7)
    buffer_load_dwordx4 v[112:115], v11, s[40:43], s69 offen offset:0 nt
    s_waitcnt vmcnt(7)
    buffer_load_dwordx4 v[116:119], v11, s[40:43], s69 offen offset:256 nt
    s_waitcnt vmcnt(7)
    buffer_load_dwordx4 v[120:123], v11, s[40:43], s69 offen offset:2048 nt
    s_waitcnt vmcnt(7)
    buffer_load_dwordx4 v[124:127], v11, s[40:43], s69 offen offset:2304 nt
    s_cmp_ge_u32 s64, 4
    s_cbranch_scc1 L_kv_done
    s_waitcnt vmcnt(7)
    buffer_load_dwordx4 v[128:131], v11, s[40:43], s70 offen offset:0 nt
    s_waitcnt vmcnt(7)
    buffer_load_dwordx4 v[132:135], v11, s[40:43], s70 offen offset:256 nt
    s_waitcnt vmcnt(7)
    buffer_load_dwordx4 v[136:139], v11, s[40:43], s70 offen offset:2048 nt
    s_waitcnt vmcnt(7)
    buffer_load_dwordx4 v[140:143], v11, s[40:43], s70 offen offset:2304 nt
    s_waitcnt vmcnt(7)
    buffer_load_dwordx4 v[144:147], v11, s[40:43], s71 offen offset:0 nt
    s_waitcnt vmcnt(7)
    buffer_load_dwordx4 v[148:151], v11, s[40:43], s71 offen offset:256 nt
    s_waitcnt vmcnt(7)
    buffer_load_dwordx4 v[152:155], v11, s[40:43], s71 offen offset:2048 nt
    s_waitcnt vmcnt(7)
    buffer_load_dwordx4 v[156:159], v11, s[40:43], s71 offen offset:2304 nt
    s_waitcnt vmcnt(7)
    ds_write_b32 v6, v0 offset:48
    s_setprio 0
L_kv_done:
    s_mov_b32 s60, 2000000
LW_33:
    ds_read_b32 v1, v9 offset:12
    s_waitcnt lgkmcnt(0)
    v_readfirstlane_b32 s61, v1
    s_cmp_ge_u32 s61, 1
    s_cbranch_scc1 LD_34
    s_sleep 2
    s_sub_u32 s60, s60, 1
    s_cbranch_scc0 LW_33
LD_34:
    v_lshrrev_b32 v10, 3, v4
    v_lshlrev_b32 v10, 8, v10
    v_lshl_add_u32 v10, v3, 4, v10
    v_and_b32 v1, 4, v4
    v_lshl_add_u32 v10, v1, 4, v10
    ds_read_b128 v[16:19], v10 offset:128
    ds_read_b128 v[20:23], v10 offset:256
    s_waitcnt vmcnt(8) lgkmcnt(0)
    s_cmp_ge_u32 s64, 4
    v_mfma_f32_16x16x32_bf16 v[160:163], v[32:35], v[16:19], 0
    v_mfma_f32_16x16x32_bf16 v[164:167], v[40:43], v[16:19], 0
    v_mfma_f32_16x16x32_bf16 v[160:163], v[36:39], v[20:23], v[160:163]
    v_mfma_f32_16x16x32_bf16 v[164:167], v[44:47], v[20:23], v[164:167]
    v_mfma_f32_16x16x32_bf16 v[32:35], v[48:51], v[16:19], 0
    v_mfma_f32_16x16x32_bf16 v[36:39], v[56:59], v[16:19], 0
    v_mfma_f32_16x16x32_bf16 v[32:35], v[52:55], v[20:23], v[32:35]
    v_mfma_f32_16x16x32_bf16 v[36:39], v[60:63], v[20:23], v[36:39]
    v_mfma_f32_16x16x32_bf16 v[48:51], v[64:67], v[16:19], 0
    v_mfma_f32_16x16x32_bf16 v[52:55], v[72:75], v[16:19], 0
    v_mfma_f32_16x16x32_bf16 v[48:51], v[68:71], v[20:23], v[48:51]
    v_mfma_f32_16x16x32_bf16 v[52:55], v[76:79], v[20:23], v[52:55]
    v_mfma_f32_16x16x32_bf16 v[64:67], v[80:83], v[16:19], 0
    v_mfma_f32_16x16x32_bf16 v[68:71], v[88:91], v[16:19], 0
    v_mfma_f32_16x16x32_bf16 v[64:67], v[84:87], v[20:23], v[64:67]
    v_mfma_f32_16x16x32_bf16 v[68:71], v[92:95], v[20:23], v[68:71]
    s_mov_b32 s72, 0x3db504f3
    s_mov_b32 s73, 0x3fb8aa3b
    v_add_f32_dpp v161, v161, v160 row_shl:4 row_mask:0xf bank_mask:0x5
    v_add_f32_dpp v163, v163, v162 row_shl:4 row_mask:0xf bank_mask:0x5
    v_add_f32_dpp v165, v165, v164 row_shl:4 row_mask:0xf bank_mask:0x5
    v_add_f32_dpp v167, v167, v166 row_shl:4 row_mask:0xf bank_mask:0x5
    v_add_f32_dpp v161, v160, v161 row_shr:4 row_mask:0xf bank_mask:0xa
    v_add_f32_dpp v163, v162, v163 row_shr:4 row_mask:0xf bank_mask:0xa
    v_add_f32_dpp v165, v164, v165 row_shr:4 row_mask:0xf bank_mask:0xa
    v_add_f32_dpp v167, v166, v167 row_shr:4 row_mask:0xf bank_mask:0xa
    v_add_f32_dpp v33, v33, v32 row_shl:4 row_mask:0xf bank_mask:0x5
    v_add_f32_dpp v35, v35, v34 row_shl:4 row_mask:0xf bank_mask:0x5
    v_add_f32_dpp v37, v37, v36 row_shl:4 row_mask:0xf bank_mask:0x5
    v_add_f32_dpp v39, v39, v38 row_shl:4 row_mask:0xf bank_mask:0x5
    v_add_f32_dpp v33, v32, v33 row_shr:4 row_mask:0xf bank_mask:0xa
    v_add_f32_dpp v35, v34, v35 row_shr:4 row_mask:0xf bank_mask:0xa
    s_cbranch_scc0 LB_35
    s_waitcnt vmcnt(7)
    buffer_load_dwordx4 v[128:131], v11, s[40:43], s70 offen offset:0 nt
LB_35:
    v_add_f32_dpp v37, v36, v37 row_shr:4 row_mask:0xf bank_mask:0xa
    v_add_f32_dpp v39, v38, v39 row_shr:4 row_mask:0xf bank_mask:0xa
    v_add_f32_dpp v49, v49, v48 row_shl:4 row_mask:0xf bank_mask:0x5
    v_add_f32_dpp v51, v51, v50 row_shl:4 row_mask:0xf bank_mask:0x5
    v_add_f32_dpp v53, v53, v52 row_shl:4 row_mask:0xf bank_mask:0x5
    v_add_f32_dpp v55, v55, v54 row_shl:4 row_mask:0xf bank_mask:0x5
    v_add_f32_dpp v49, v48, v49 row_shr:4 row_mask:0xf bank_mask:0xa
    v_add_f32_dpp v51, v50, v51 row_shr:4 row_mask:0xf bank_mask:0xa
    v_add_f32_dpp v53, v52, v53 row_shr:4 row_mask:0xf bank_mask:0xa
    v_add_f32_dpp v55, v54, v55 row_shr:4 row_mask:0xf bank_mask:0xa
    v_add_f32_dpp v65, v65, v64 row_shl:4 row_mask:0xf bank_mask:0x5
    v_add_f32_dpp v67, v67, v66 row_shl:4 row_mask:0xf bank_mask:0x5
    v_add_f32_dpp v69, v69, v68 row_shl:4 row_mask:0xf bank_mask:0x5
    v_add_f32_dpp v71, v71, v70 row_shl:4 row_mask:0xf bank_mask:0x5
    v_add_f32_dpp v65, v64, v65 row_shr:4 row_mask:0xf bank_mask:0xa
    v_add_f32_dpp v67, v66, v67 row_shr:4 row_mask:0xf bank_mask:0xa
    v_add_f32_dpp v69, v68, v69 row_shr:4 row_mask:0xf bank_mask:0xa
    v_add_f32_dpp v71, v70, v71 row_shr:4 row_mask:0xf bank_mask:0xa
    v_cvt_pk_bf16_f32 v161, v161, v163
    v_and_b32 v163, 0xffff0000, v161
    v_lshlrev_b32 v161, 16, v161
    v_mul_f32 v161, s72, v161
    v_mul_f32 v163, s72, v163
    v_cvt_pk_bf16_f32 v161, v161, v163
    v_and_b32 v17, 0xffff0000, v161
    v_lshlrev_b32 v16, 16, v161
    v_cvt_pk_bf16_f32 v165, v165, v167
    v_and_b32 v167, 0xffff0000, v165
    v_lshlrev_b32 v165, 16, v165
    v_mul_f32 v165, s72, v165
    v_mul_f32 v167, s72, v167
    v_cvt_pk_bf16_f32 v165, v165, v167
    s_cbranch_scc0 LB_36
    s_waitcnt vmcnt(7)
    buffer_load_dwordx4 v[132:135], v11, s[40:43], s70 offen offset:256 nt
LB_36:
    v_and_b32 v19, 0xffff0000, v165
    v_lshlrev_b32 v18, 16, v165
    v_cvt_pk_bf16_f32 v33, v33, v35
    v_and_b32 v35, 0xffff0000, v33
    v_lshlrev_b32 v33, 16, v33
    v_mul_f32 v33, s72, v33
    v_mul_f32 v35, s72, v35
    v_cvt_pk_bf16_f32 v33, v33, v35
    v_and_b32 v21, 0xffff0000, v33
    v_lshlrev_b32 v20, 16, v33
    v_cvt_pk_bf16_f32 v37, v37, v39
    v_and_b32 v39, 0xffff0000, v37
    v_lshlrev_b32 v37, 16, v37
    v_mul_f32 v37, s72, v37
    v_mul_f32 v39, s72, v39
    v_cvt_pk_bf16_f32 v37, v37, v39
    v_and_b32 v23, 0xffff0000, v37
    v_lshlrev_b32 v22, 16, v37
    v_cvt_pk_bf16_f32 v49, v49, v51
    v_and_b32 v51, 0xffff0000, v49
    v_lshlrev_b32 v49, 16, v49
    v_mul_f32 v49, s72, v49
    v_mul_f32 v51, s72, v51
    v_cvt_pk_bf16_f32 v49, v49, v51
    v_and_b32 v25, 0xffff0000, v49
    v_lshlrev_b32 v24, 16, v49
    v_cvt_pk_bf16_f32 v53, v53, v55
    v_and_b32 v55, 0xffff0000, v53
    v_lshlrev_b32 v53, 16, v53
    v_mul_f32 v53, s72, v53
    v_mul_f32 v55, s72, v55
    s_cbranch_scc0 LB_37
    s_waitcnt vmcnt(7)
    buffer_load_dwordx4 v[136:139], v11, s[40:43], s70 offen offset:2048 nt
LB_37:
    v_cvt_pk_bf16_f32 v53, v53, v55
    v_and_b32 v27, 0xffff0000, v53
    v_lshlrev_b32 v26, 16, v53
    v_cvt_pk_bf16_f32 v65, v65, v67
    v_and_b32 v67, 0xffff0000, v65
    v_lshlrev_b32 v65, 16, v65
    v_mul_f32 v65, s72, v65
    v_mul_f32 v67, s72, v67
    v_cvt_pk_bf16_f32 v65, v65, v67
    v_and_b32 v29, 0xffff0000, v65
    v_lshlrev_b32 v28, 16, v65
    v_cvt_pk_bf16_f32 v69, v69, v71
    v_and_b32 v71, 0xffff0000, v69
    v_lshlrev_b32 v69, 16, v69
    v_mul_f32 v69, s72, v69
    v_mul_f32 v71, s72, v71
    v_cvt_pk_bf16_f32 v69, v69, v71
    v_and_b32 v31, 0xffff0000, v69
    v_lshlrev_b32 v30, 16, v69
    v_max3_f32 v164, v16, v17, v18
    v_max3_f32 v164, v164, v19, v20
    v_max3_f32 v164, v164, v21, v22
    v_max3_f32 v164, v164, v23, v24
    v_max3_f32 v164, v164, v25, v26
    v_max3_f32 v164, v164, v27, v28
    v_max3_f32 v164, v164, v29, v30
    v_max_f32 v164, v164, v31
    v_mov_b32 v165, v164
    s_nop 1
    v_permlane16_swap_b32 v164, v165
    s_nop 0
    v_max_f32 v164, v164, v165
    s_cbranch_scc0 LB_38
    s_waitcnt vmcnt(7)
    buffer_load_dwordx4 v[140:143], v11, s[40:43], s70 offen offset:2304 nt
LB_38:
    v_mov_b32 v165, v164
    s_nop 1
    v_permlane32_swap_b32 v164, v165
    s_nop 0
    v_max_f32 v164, v164, v165
    v_sub_f32 v16, v16, v164
    v_sub_f32 v17, v17, v164
    v_sub_f32 v18, v18, v164
    v_sub_f32 v19, v19, v164
    v_sub_f32 v20, v20, v164
    v_sub_f32 v21, v21, v164
    v_sub_f32 v22, v22, v164
    v_sub_f32 v23, v23, v164
    v_sub_f32 v24, v24, v164
    v_sub_f32 v25, v25, v164
    v_sub_f32 v26, v26, v164
    v_sub_f32 v27, v27, v164
    v_sub_f32 v28, v28, v164
    v_sub_f32 v29, v29, v164
    v_sub_f32 v30, v30, v164
    v_sub_f32 v31, v31, v164
    v_mul_f32 v16, s73, v16
    v_mul_f32 v17, s73, v17
    v_mul_f32 v18, s73, v18
    v_mul_f32 v19, s73, v19
    v_mul_f32 v20, s73, v20
    v_mul_f32 v21, s73, v21
    v_mul_f32 v22, s73, v22
    v_mul_f32 v23, s73, v23
    v_mul_f32 v24, s73, v24
    v_mul_f32 v25, s73, v25
    v_mul_f32 v26, s73, v26
    s_cbranch_scc0 LB_39
    s_waitcnt vmcnt(7)
    buffer_load_dwordx4 v[144:147], v11, s[40:43], s71 offen offset:0 nt
LB_39:
    v_mul_f32 v27, s73, v27
    v_mul_f32 v28, s73, v28
    v_mul_f32 v29, s73, v29
    v_mul_f32 v30, s73, v30
    v_mul_f32 v31, s73, v31
    v_exp_f32 v16, v16
    v_exp_f32 v17, v17
    v_exp_f32 v18, v18
    v_exp_f32 v19, v19
    v_exp_f32 v20, v20
    v_exp_f32 v21, v21
    v_exp_f32 v22, v22
    v_exp_f32 v23, v23
    v_exp_f32 v24, v24
    v_exp_f32 v25, v25
    v_exp_f32 v26, v26
    v_exp_f32 v27, v27
    v_exp_f32 v28, v28
    v_exp_f32 v29, v29
    v_exp_f32 v30, v30
    v_exp_f32 v31, v31
    v_add_f32 v165, v16, v17
    v_add_f32 v165, v165, v18
    v_add_f32 v165, v165, v19
    v_add_f32 v165, v165, v20
    v_add_f32 v165, v165, v21
    v_add_f32 v165, v165, v22
    v_add_f32 v165, v165, v23
    v_add_f32 v165, v165, v24
    v_add_f32 v165, v165, v25
    v_add_f32 v165, v165, v26
    s_cbranch_scc0 LB_40
    s_waitcnt vmcnt(7)
    buffer_load_dwordx4 v[148:151], v11, s[40:43], s71 offen offset:256 nt
LB_40:
    v_add_f32 v165, v165, v27
    v_add_f32 v165, v165, v28
    v_add_f32 v165, v165, v29
    v_add_f32 v165, v165, v30
    v_add_f32 v165, v165, v31
    v_cvt_pk_bf16_f32 v16, v16, v16
    v_cvt_pk_bf16_f32 v17, v17, v17
    v_cvt_pk_bf16_f32 v18, v18, v18
    v_cvt_pk_bf16_f32 v19, v19, v19
    v_cvt_pk_bf16_f32 v20, v20, v20
    v_cvt_pk_bf16_f32 v21, v21, v21
    v_cvt_pk_bf16_f32 v22, v22, v22
    v_cvt_pk_bf16_f32 v23, v23, v23
    v_cvt_pk_bf16_f32 v24, v24, v24
    v_cvt_pk_bf16_f32 v25, v25, v25
    v_cvt_pk_bf16_f32 v26, v26, v26
    v_cvt_pk_bf16_f32 v27, v27, v27
    v_cvt_pk_bf16_f32 v28, v28, v28
    v_cvt_pk_bf16_f32 v29, v29, v29
    v_cvt_pk_bf16_f32 v30, v30, v30
    v_cvt_pk_bf16_f32 v31, v31, v31
    v_mov_b32 v1, v165
    s_nop 1
    v_permlane16_swap_b32 v165, v1
    s_nop 0
    v_add_f32 v165, v165, v1
    v_mov_b32 v1, v165
    s_nop 1
    v_permlane32_swap_b32 v165, v1
    s_nop 0
    v_add_f32 v165, v165, v1
    v_and_b32 v32, v16, v12
    s_cbranch_scc0 LB_41
    s_waitcnt vmcnt(7)
    buffer_load_dwordx4 v[152:155], v11, s[40:43], s71 offen offset:2048 nt
LB_41:
    v_and_b32 v33, v16, v13
    v_and_b32 v34, v16, v14
    v_and_b32 v35, v16, v15
    v_and_b32 v36, v17, v12
    v_and_b32 v37, v17, v13
    v_and_b32 v38, v17, v14
    v_and_b32 v39, v17, v15
    v_and_b32 v40, v18, v12
    v_and_b32 v41, v18, v13
    v_and_b32 v42, v18, v14
    v_and_b32 v43, v18, v15
    v_and_b32 v44, v19, v12
    v_and_b32 v45, v19, v13
    v_and_b32 v46, v19, v14
    v_and_b32 v47, v19, v15
    v_and_b32 v48, v20, v12
    v_and_b32 v49, v20, v13
    v_and_b32 v50, v20, v14
    v_and_b32 v51, v20, v15
    v_and_b32 v52, v21, v12
    v_and_b32 v53, v21, v13
    v_and_b32 v54, v21, v14
    v_and_b32 v55, v21, v15
    v_and_b32 v56, v22, v12
    v_and_b32 v57, v22, v13
    v_and_b32 v58, v22, v14
    v_and_b32 v59, v22, v15
    v_and_b32 v60, v23, v12
    v_and_b32 v61, v23, v13
    v_and_b32 v62, v23, v14
    v_and_b32 v63, v23, v15
    v_and_b32 v64, v24, v12
    s_cbranch_scc0 LB_42
    s_waitcnt vmcnt(7)
    buffer_load_dwordx4 v[156:159], v11, s[40:43], s71 offen offset:2304 nt
    s_mov_b64 exec, 1
    ds_add_u32 v9, v0 offset:20
    s_mov_b64 exec, -1
    s_mov_b64 exec, 1
    ds_add_u32 v9, v0 offset:20
    s_mov_b64 exec, -1
LB_42:
    v_and_b32 v65, v24, v13
    v_and_b32 v66, v24, v14
    v_and_b32 v67, v24, v15
    v_and_b32 v68, v25, v12
    v_and_b32 v69, v25, v13
    v_and_b32 v70, v25, v14
    v_and_b32 v71, v25, v15
    v_and_b32 v72, v26, v12
    v_and_b32 v73, v26, v13
    v_and_b32 v74, v26, v14
    v_and_b32 v75, v26, v15
    v_and_b32 v76, v27, v12
    v_and_b32 v77, v27, v13
    v_and_b32 v78, v27, v14
    v_and_b32 v79, v27, v15
    v_and_b32 v80, v28, v12
    v_and_b32 v81, v28, v13
    v_and_b32 v82, v28, v14
    v_and_b32 v83, v28, v15
    v_and_b32 v84, v29, v12
    v_and_b32 v85, v29, v13
    v_and_b32 v86, v29, v14
    v_and_b32 v87, v29, v15
    v_and_b32 v88, v30, v12
    v_and_b32 v89, v30, v13
    v_and_b32 v90, v30, v14
    v_and_b32 v91, v30, v15
    v_and_b32 v92, v31, v12
    v_and_b32 v93, v31, v13
    v_and_b32 v94, v31, v14
    v_and_b32 v95, v31, v15
    v_lshlrev_b32 v10, 2, v2
    s_lshl_b32 s66, s64, 2
    v_add_u32 v10, s66, v10
    s_mov_b64 exec, 0x101
    ds_write2_b32 v10, v164, v165 offset0:160 offset1:176
    s_mov_b64 exec, -1
    s_cmp_lt_u32 s64, 4
    s_cbranch_scc1 L_nocount
    s_mov_b64 exec, 1
    ds_add_u32 v9, v0 offset:16
    s_mov_b64 exec, -1
L_nocount:
    s_waitcnt vmcnt(15)
    v_mfma_f32_16x16x32_bf16 v[160:163], v[32:35], v[96:99], 0
    s_waitcnt vmcnt(14)
    v_mfma_f32_16x16x32_bf16 v[160:163], v[36:39], v[100:103], v[160:163]
    s_waitcnt vmcnt(13)
    v_mfma_f32_16x16x32_bf16 v[160:163], v[40:43], v[104:107], v[160:163]
    s_waitcnt vmcnt(12)
    v_mfma_f32_16x16x32_bf16 v[160:163], v[44:47], v[108:111], v[160:163]
    s_waitcnt vmcnt(11)
    v_mfma_f32_16x16x32_bf16 v[160:163], v[48:51], v[112:115], v[160:163]
    s_waitcnt vmcnt(10)
    v_mfma_f32_16x16x32_bf16 v[160:163], v[52:55], v[116:119], v[160:163]
    s_waitcnt vmcnt(9)
    v_mfma_f32_16x16x32_bf16 v[160:163], v[56:59], v[120:123], v[160:163]
    s_waitcnt vmcnt(8)
    v_mfma_f32_16x16x32_bf16 v[160:163], v[60:63], v[124:127], v[160:163]
    s_lshl_b32 s67, s64, 10
    v_add_u32 v8, s67, v7
    v_lshrrev_b32 v167, 1, v3
    v_lshlrev_b32 v166, 5, v167
    v_lshrrev_b32 v10, 2, v4
    v_lshl_add_u32 v10, v167, 2, v10
    v_lshlrev_b32 v10, 11, v10
    v_and_b32 v1, 3, v4
    v_lshl_add_u32 v10, v1, 5, v10
    v_and_b32 v1, 1, v3
    v_lshl_add_u32 v10, v1, 4, v10
    v_lshl_add_u32 v1, v4, 1, v1
    v_lshl_add_u32 v1, v167, 5, v1
    v_lshlrev_b32 v28, 8, v1
    v_lshlrev_b32 v167, 8, v167
    v_mov_b32 v18, s14
    v_mov_b32 v19, s15
    v_mov_b32 v29, 0xffffff00
    v_mov_b32 v20, 1.0
    v_mov_b32 v24, 0
    v_mov_b32 v25, 0
    v_mov_b32 v26, 0
    v_mov_b32 v27, 0
    s_cmp_lt_u32 s64, 4
    s_cbranch_scc1 L_own_max
    s_mov_b32 s60, 2000000
LW_43:
    ds_read_b32 v1, v9 offset:16
    s_waitcnt lgkmcnt(0)
    v_readfirstlane_b32 s61, v1
    s_cmp_ge_u32 s61, 8
    s_cbranch_scc1 LD_44
    s_sleep 1
    s_sub_u32 s60, s60, 1
    s_cbranch_scc0 LW_43
LD_44:
    v_add_u32 v11, s66, v166
    ds_read_b128 v[32:35], v166 offset:640
    ds_read_b128 v[36:39], v166 offset:656
    ds_read_b128 v[40:43], v166 offset:704
    ds_read_b128 v[44:47], v166 offset:720
    ds_read_b32 v20, v11 offset:640
    ds_read_b32 v48, v11 offset:624
    ds_read_b128 v[24:27], v8 offset:17792
    s_waitcnt lgkmcnt(0)
    v_max3_f32 v11, v32, v33, v34
    v_max3_f32 v1, v35, v36, v37
    v_max3_f32 v11, v11, v38, v39
    v_max_f32 v11, v11, v1
    v_sub_f32 v20, v20, v11
    v_sub_f32 v48, v48, v11
    v_sub_f32 v32, v32, v11
    v_sub_f32 v33, v33, v11
    v_sub_f32 v34, v34, v11
    v_sub_f32 v35, v35, v11
    v_sub_f32 v36, v36, v11
    v_sub_f32 v37, v37, v11
    v_sub_f32 v38, v38, v11
    v_sub_f32 v39, v39, v11
    v_mul_f32 v20, s73, v20
    v_mul_f32 v48, s73, v48
    v_mul_f32 v32, s73, v32
    v_mul_f32 v33, s73, v33
    v_mul_f32 v34, s73, v34
    v_mul_f32 v35, s73, v35
    v_mul_f32 v36, s73, v36
    v_mul_f32 v37, s73, v37
    v_mul_f32 v38, s73, v38
    v_mul_f32 v39, s73, v39
    v_exp_f32 v20, v20
    v_exp_f32 v48, v48
    v_exp_f32 v32, v32
    v_exp_f32 v33, v33
    v_exp_f32 v34, v34
    v_exp_f32 v35, v35
    v_exp_f32 v36, v36
    v_exp_f32 v37, v37
    v_exp_f32 v38, v38
    v_exp_f32 v39, v39
    v_mul_f32 v24, v48, v24
    v_mul_f32 v25, v48, v25
    v_mul_f32 v26, v48, v26
    v_mul_f32 v27, v48, v27
    v_mul_f32 v17, v32, v40
    v_fmac_f32 v17, v33, v41
    v_fmac_f32 v17, v34, v42
    v_fmac_f32 v17, v35, v43
    v_fmac_f32 v17, v36, v44
    v_fmac_f32 v17, v37, v45
    v_fmac_f32 v17, v38, v46
    v_fmac_f32 v17, v39, v47
    v_or_b32 v16, s32, v11
    v_and_or_b32 v17, v17, v29, s33
    s_cmp_lt_u32 s64, 4
L_own_max:
    s_waitcnt vmcnt(7)
    v_mfma_f32_16x16x32_bf16 v[160:163], v[64:67], v[128:131], v[160:163]
    s_waitcnt vmcnt(6)
    v_mfma_f32_16x16x32_bf16 v[160:163], v[68:71], v[132:135], v[160:163]
    s_waitcnt vmcnt(5)
    v_mfma_f32_16x16x32_bf16 v[160:163], v[72:75], v[136:139], v[160:163]
    s_waitcnt vmcnt(4)
    v_mfma_f32_16x16x32_bf16 v[160:163], v[76:79], v[140:143], v[160:163]
    s_waitcnt vmcnt(3)
    v_mfma_f32_16x16x32_bf16 v[160:163], v[80:83], v[144:147], v[160:163]
    s_waitcnt vmcnt(2)
    v_mfma_f32_16x16x32_bf16 v[160:163], v[84:87], v[148:151], v[160:163]
    s_waitcnt vmcnt(1)
    v_mfma_f32_16x16x32_bf16 v[160:163], v[88:91], v[152:155], v[160:163]
    s_waitcnt vmcnt(0)
    v_mfma_f32_16x16x32_bf16 v[160:163], v[92:95], v[156:159], v[160:163]
    s_nop 7
    v_fma_f32 v160, v20, v160, v24
    v_fma_f32 v161, v20, v161, v25
    v_fma_f32 v162, v20, v162, v26
    v_fma_f32 v163, v20, v163, v27
    ds_write_b128 v8, v[160:163] offset:21888
    s_cbranch_scc1 L_a_done
    s_mov_b64 exec, 1
    ds_add_rtn_u32 v1, v9, v0 offset:0
    s_mov_b64 exec, -1
    ds_read_b128 v[32:35], v7 offset:25984
    ds_read_b128 v[36:39], v7 offset:27008
    ds_read_b128 v[40:43], v7 offset:28032
    ds_read_b128 v[44:47], v7 offset:29056
    s_waitcnt lgkmcnt(4)
    v_readfirstlane_b32 s61, v1
    s_cmp_lg_u32 s61, 3
    s_cbranch_scc1 L_notlast
    s_waitcnt lgkmcnt(2)
    v_pk_add_f32 v[160:161], v[32:33], v[36:37]
    v_pk_add_f32 v[162:163], v[34:35], v[38:39]
    s_waitcnt lgkmcnt(0)
    v_pk_add_f32 v[40:41], v[40:41], v[44:45]
    v_pk_add_f32 v[42:43], v[42:43], v[46:47]
    v_pk_add_f32 v[160:161], v[160:161], v[40:41]
    v_pk_add_f32 v[162:163], v[162:163], v[42:43]
    v_and_or_b32 v160, v160, v29, s32
    v_and_or_b32 v161, v161, v29, s33
    v_and_or_b32 v162, v162, v29, s34
    v_and_or_b32 v163, v163, v29, s35
    buffer_store_dwordx4 v[160:163], v28, s[28:31], s56 offen
    s_mov_b32 exec_lo, 1
    s_mov_b32 exec_hi, 1
    buffer_store_dwordx4 v[16:19], v167, s[28:31], s58 offen
    s_mov_b64 exec, -1
    ds_write_b32 v9, v0 offset:24
    s_cmp_ge_u32 s55, 18
    s_cbranch_scc1 L_gstore
    s_mov_b32 s60, 40
L_gwait:
    ds_read_b32 v1, v9 offset:28
    s_waitcnt lgkmcnt(0)
    v_readfirstlane_b32 s61, v1
    s_cmp_lg_u32 s61, 0
    s_cbranch_scc1 L_gstore
    s_sleep 2
    s_sub_u32 s60, s60, 1
    s_cbranch_scc0 L_gwait
L_gstore:
    buffer_store_dwordx4 v[160:163], v10, s[28:31], s57 offen sc1
    s_mov_b32 exec_lo, 1
    s_mov_b32 exec_hi, 1
    buffer_store_dwordx4 v[16:19], v167, s[28:31], s59 offen sc1
    s_mov_b64 exec, -1
    s_mov_b32 s61, 3
L_notlast:
    s_cmp_lt_u32 s2, 238
    s_cbranch_scc1 L_fin
    s_cmp_lt_u32 s61, 2
    s_cbranch_scc1 L_fin
    s_and_b32 s74, s61, 1
    s_sub_u32 s62, s2, 238
    s_and_b32 s63, s62, 1
    s_lshr_b32 s62, s62, 1
    s_mov_b32 s48, s22
    s_mov_b32 s49, s23
    s_mov_b32 s50, 2304
    s_mov_b32 s51, 0x20000
    s_mov_b32 s44, s4
    s_mov_b32 s45, s5
    s_mov_b32 s46, 2304
    s_mov_b32 s47, 0x20000
    v_lshrrev_b32 v10, 3, v2
    v_lshlrev_b32 v10, 9, v10
    v_lshl_add_u32 v10, v5, 4, v10
    v_and_b32 v1, 0x7ff, v10
    v_mov_b32 v30, v1
    v_cmp_gt_u32 vcc, 32, v2
    s_lshl_b32 s66, s63, 8
    s_lshl_b32 s67, s74, 7
    v_cndmask_b32 v31, 0, 1.0, vcc
    s_add_u32 s66, s66, s67
    s_add_u32 s66, s66, 1310720
    s_mul_i32 s67, s62, 6144
    s_add_u32 s67, s67, s66
    s_lshl_b32 s68, s62, 13
    s_add_u32 s68, s68, s66
    s_add_u32 s68, s68, 55296
    s_add_u32 s69, s68, 4096
    s_add_u32 s70, s67, 4096
    v_lshl_add_u32 v11, v5, 2, v3
    v_lshlrev_b32 v11, 1, v11
    s_mul_i32 s71, s63, 1152
    s_lshl_b32 s72, s62, 7
    s_add_u32 s71, s71, s72
    s_lshl_b32 s72, s74, 6
    s_add_u32 s71, s71, s72
    s_waitcnt lgkmcnt(0)
    buffer_load_ushort v24, v11, s[44:47], s71 offen
    s_mov_b32 s72, 1441792
    s_mov_b32 s60, 2000000
LP_45:
    buffer_load_dwordx4 v[128:131], v10, s[28:31], s67 offen sc1
    buffer_load_dwordx4 v[132:135], v30, s[28:31], s70 offen sc1
    buffer_load_dwordx4 v[96:99], v10, s[28:31], s68 offen sc1
    buffer_load_dwordx4 v[100:103], v10, s[28:31], s69 offen sc1
    s_waitcnt vmcnt(2)
    v_xor_b32 v32, s32, v128
    v_xor_b32 v33, s33, v129
    v_xor_b32 v34, s34, v130
    v_xor_b32 v35, s35, v131
    v_xor_b32 v36, s32, v132
    v_xor_b32 v37, s33, v133
    v_xor_b32 v38, s34, v134
    v_xor_b32 v39, s35, v135
    v_or3_b32 v64, v32, v33, v34
    v_or3_b32 v65, v35, v36, v37
    v_or3_b32 v66, v64, v65, v38
    v_or_b32 v67, v66, v39
    v_and_b32 v68, 0xff, v67
    v_cmp_ne_u32 vcc, 0, v68
    s_cbranch_vccz LK_46
    s_sleep 1
    s_sub_u32 s60, s60, 1
    s_cbranch_scc0 LP_45
LK_46:
    v_fmac_f32 v34, v31, v38
    v_fmac_f32 v32, v31, v36
    v_fmac_f32 v35, v31, v39
    v_fmac_f32 v33, v31, v37
    s_nop 0
    v_permlane32_swap_b32 v32, v34
    v_permlane32_swap_b32 v33, v35
    v_add_f32 v32, v32, v34
    v_add_f32 v33, v33, v35
    s_nop 1
    v_permlane16_swap_b32 v32, v33
    v_add_f32 v32, v32, v33
    s_nop 1
    v_add_f32_dpp v32, v32, v32 row_ror:8 row_mask:0xf bank_mask:0xf
    v_cvt_pk_bf16_f32 v32, v32, v32
    v_and_b32 v32, 0xffff0000, v32
    v_mul_f32 v33, 0xbfb8aa3b, v32
    v_exp_f32 v33, v33
    v_lshlrev_b32 v24, 16, v24
    v_add_f32 v33, 1.0, v33
    v_rcp_f32 v33, v33
    s_nop 0
    v_mul_f32 v32, v32, v33
    v_cvt_pk_bf16_f32 v32, v32, v32
    v_and_b32 v32, 0xffff0000, v32
    s_mov_b32 s60, 2000000
    buffer_load_dwordx4 v[104:107], v10, s[28:31], s68 offen sc1
    buffer_load_dwordx4 v[108:111], v10, s[28:31], s69 offen sc1
LP_47:
    buffer_load_dwordx4 v[112:115], v10, s[28:31], s68 offen sc1
    buffer_load_dwordx4 v[116:119], v10, s[28:31], s69 offen sc1
    s_waitcnt vmcnt(4)
    v_xor_b32 v44, s32, v96
    v_xor_b32 v45, s33, v97
    v_xor_b32 v46, s34, v98
    v_xor_b32 v47, s35, v99
    v_xor_b32 v48, s32, v100
    v_xor_b32 v49, s33, v101
    v_xor_b32 v50, s34, v102
    v_xor_b32 v51, s35, v103
    v_or3_b32 v64, v44, v45, v46
    v_or3_b32 v65, v47, v48, v49
    v_or3_b32 v66, v64, v65, v50
    v_or_b32 v67, v66, v51
    v_and_b32 v68, 0xff, v67
    v_cmp_ne_u32 vcc, 0, v68
    s_cbranch_vccz LK_48
    buffer_load_dwordx4 v[96:99], v10, s[28:31], s68 offen sc1
    buffer_load_dwordx4 v[100:103], v10, s[28:31], s69 offen sc1
    s_waitcnt vmcnt(4)
    v_xor_b32 v44, s32, v104
    v_xor_b32 v45, s33, v105
    v_xor_b32 v46, s34, v106
    v_xor_b32 v47, s35, v107
    v_xor_b32 v48, s32, v108
    v_xor_b32 v49, s33, v109
    v_xor_b32 v50, s34, v110
    v_xor_b32 v51, s35, v111
    v_or3_b32 v64, v44, v45, v46
    v_or3_b32 v65, v47, v48, v49
    v_or3_b32 v66, v64, v65, v50
    v_or_b32 v67, v66, v51
    v_and_b32 v68, 0xff, v67
    v_cmp_ne_u32 vcc, 0, v68
    s_cbranch_vccz LK_48
    buffer_load_dwordx4 v[104:107], v10, s[28:31], s68 offen sc1
    buffer_load_dwordx4 v[108:111], v10, s[28:31], s69 offen sc1
    s_waitcnt vmcnt(4)
    v_xor_b32 v44, s32, v112
    v_xor_b32 v45, s33, v113
    v_xor_b32 v46, s34, v114
    v_xor_b32 v47, s35, v115
    v_xor_b32 v48, s32, v116
    v_xor_b32 v49, s33, v117
    v_xor_b32 v50, s34, v118
    v_xor_b32 v51, s35, v119
    v_or3_b32 v64, v44, v45, v46
    v_or3_b32 v65, v47, v48, v49
    v_or3_b32 v66, v64, v65, v50
    v_or_b32 v67, v66, v51
    v_and_b32 v68, 0xff, v67
    v_cmp_ne_u32 vcc, 0, v68
    s_cbranch_vccz LK_48
    s_sub_u32 s60, s60, 1
    s_cbranch_scc0 LP_47
LK_48:
    v_add_f32 v46, v46, v50
    v_add_f32 v44, v44, v48
    v_add_f32 v47, v47, v51
    v_add_f32 v45, v45, v49
    s_nop 0
    v_permlane32_swap_b32 v44, v46
    v_permlane32_swap_b32 v45, v47
    v_add_f32 v44, v44, v46
    v_add_f32 v45, v45, v47
    s_nop 1
    v_permlane16_swap_b32 v44, v45
    v_add_f32 v44, v44, v45
    s_nop 1
    v_add_f32_dpp v44, v44, v44 row_ror:8 row_mask:0xf bank_mask:0xf
    v_cvt_pk_bf16_f32 v44, v44, v44
    v_and_b32 v44, 0xffff0000, v44
    v_mul_f32 v44, v32, v44
    v_cvt_pk_bf16_f32 v44, v44, v44
    v_and_b32 v44, 0xffff0000, v44
    v_add_f32 v44, v44, v24
    s_mov_b64 exec, s[52:53]
    v_cvt_pk_bf16_f32 v44, v44, v44
    buffer_store_short v44, v11, s[48:51], s71 offen
    s_lshl1_add_u32 s61, s2, s74
    s_cmp_lg_u32 s61, 511
    s_cbranch_scc1 L_noepoch
    s_mov_b64 exec, 1
    buffer_store_dwordx2 v[18:19], v9, s[28:31], s72 offen sc1
L_noepoch:
L_fin:
L_end:
    s_endpgm
L_a_done:
    s_waitcnt lgkmcnt(0)
    s_mov_b64 exec, 1
    ds_add_u32 v9, v0 offset:16
    s_mov_b64 exec, -1
    s_branch L_p3
L_last:
.section .rodata,"a"
.p2align 6
.amdhsa_kernel recurrent_scan__sliding_block_cached__glu_gated_reglu__decode_kernel
  .amdhsa_next_free_vgpr 168
  .amdhsa_next_free_sgpr 102
  .amdhsa_accum_offset 168
  .amdhsa_group_segment_fixed_size 0
  .amdhsa_kernarg_size 96
  .amdhsa_user_sgpr_count 2
  .amdhsa_user_sgpr_kernarg_segment_ptr 1
  .amdhsa_system_sgpr_workgroup_id_x 1
  .amdhsa_float_denorm_mode_32 3
  .amdhsa_float_denorm_mode_16_64 3
.end_amdhsa_kernel
```
